```python
import torch

def _softmax(x, axis=-1):
    return torch.softmax(x, dim=axis)
def _gelu(x):
    return torch.nn.functional.gelu(x, approximate="tanh")
def _silu(x):
    return torch.nn.functional.silu(x)
def _sigmoid(x):
    return torch.sigmoid(x)
def _layernorm(x, axis=-1, eps=1e-5):
    m = x.mean(dim=axis, keepdim=True)
    v = x.var(dim=axis, keepdim=True, unbiased=False)
    return (x - m) / torch.sqrt(v + eps)
def _scatter_add(tgt, idx, src, axis=0):
    return tgt.clone().index_add_(axis, idx, src)
def _segment_sum(src, seg, n):
    out = torch.zeros((n,) + src.shape[1:], dtype=src.dtype)
    return out.index_add_(0, seg, src)
def _pad(x, pw):
    flat = tuple(v for pair in reversed(pw) for v in pair)
    return torch.nn.functional.pad(x, flat)

kernel_name = 'standalone__glu_gated_bilinear__prompt'

def setup_inputs():

    _w = (lambda a: (lambda t: t.to(torch.bfloat16) if t.is_floating_point() else t)(torch.as_tensor(a)))
    B, S, D, F = 1, 2048, 512, 1792
    return {
        "x": _w((lambda *s: torch.randn(*s, dtype=torch.bfloat16) * 0.05)(B, S, D)),
        "w_gate": _w((lambda *s: torch.randn(*s, dtype=torch.bfloat16) * 0.05)(D, F) * (D ** -0.5)),
        "w_up": _w((lambda *s: torch.randn(*s, dtype=torch.bfloat16) * 0.05)(D, F) * (D ** -0.5)),
        "w_down": _w((lambda *s: torch.randn(*s, dtype=torch.bfloat16) * 0.05)(F, D) * (F ** -0.5)),
    }

def reference(x, w_gate, w_up, w_down):
    g = torch.einsum("bsd,df->bsf", x, w_gate)
    u = torch.einsum("bsd,df->bsf", x, w_up)
    h = g * u
    return torch.einsum("bsf,fd->bsd", h, w_down)
```

```asm
; @launch grid=(256,1,1) block=(256,1,1) lds=163840
.amdgcn_target "amdgcn-amd-amdhsa--gfx950"
.text
.p2align 12
.globl standalone__glu_gated_bilinear__prompt_kernel
.p2align 8
.type standalone__glu_gated_bilinear__prompt_kernel,@function
standalone__glu_gated_bilinear__prompt_kernel:
    s_load_dwordx2 s[8:9], s[0:1], 0
    s_load_dwordx2 s[12:13], s[0:1], 8
    s_load_dwordx2 s[16:17], s[0:1], 16
    s_load_dwordx2 s[20:21], s[0:1], 24
    s_load_dwordx2 s[28:29], s[0:1], 32
    s_load_dwordx2 s[32:33], s[0:1], 40
    s_load_dwordx2 s[24:25], s[0:1], 48
    s_cmp_ge_u32 s2, 256
    s_cbranch_scc1 L_end
    s_getpc_b64 s[4:5]
    s_and_b32 s4, s4, 0xffffff00
    v_lshlrev_b32 v30, 7, v0
    v_mov_b32 v29, s5
    v_add_co_u32 v28, vcc, s4, v30
    v_addc_co_u32 v29, vcc, 0, v29, vcc
    v_cmp_gt_u32 vcc, L_codeend-standalone__glu_gated_bilinear__prompt_kernel, v30
    s_and_saveexec_b64 s[4:5], vcc
    s_cbranch_execz L_nopf
    global_load_dword v31, v[28:29], off
L_nopf:
    s_mov_b64 exec, -1
    v_lshrrev_b32 v30, 6, v0
    v_and_b32 v0, 63, v0
    v_readfirstlane_b32 s36, v30
    s_and_b32 s55, s2, 7
    s_bfe_u32 s57, s2, 0x20003
    s_lshr_b32 s56, s2, 5
    s_lshr_b32 s37, s55, 1
    s_lshl_b32 s37, s37, 2
    s_add_u32 s37, s37, s57
    s_and_b32 s38, s55, 1
    s_mul_i32 s38, s38, 7
    s_add_u32 s38, s38, s56
    s_sub_u32 s38, s38, 1
    v_lshrrev_b32 v240, 3, v0
    v_and_b32 v241, 7, v0
    v_lshrrev_b32 v242, 4, v0
    s_xor_b32 s59, s36, s56
    s_and_b32 s59, s59, 3
    s_mul_i32 s7, s59, 20480
    s_add_u32 s7, s7, 81920
    s_lshl_b32 s58, s59, 15
    v_xor_b32 v243, v241, v242
    v_lshlrev_b32 v243, 4, v243
    v_lshl_add_u32 v1, v240, 10, v243
    v_add_u32 v1, s58, v1
    v_xor_b32 v2, 64, v1
    v_add_u32 v2, 7168, v2
    v_add_u32 v3, 14336, v1
    v_add_u32 v4, 14336, v2
    s_lshr_b32 s58, s36, 1
    s_lshl_b32 s58, s58, 5
    s_and_b32 s59, s36, 1
    s_lshl_b32 s46, s59, 3
    s_add_u32 s58, s58, s46
    s_mul_i32 s58, s58, 3584
    s_lshl_b32 s59, s59, 6
    v_mul_u32_u24 v5, 3584, v240
    v_and_b32 v244, 1, v242
    v_lshlrev_b32 v245, 4, v241
    v_lshlrev_b32 v246, 5, v244
    v_xor_b32 v246, v245, v246
    v_xor_b32 v246, s59, v246
    v_add3_u32 v5, v5, v246, s58
    v_add_u32 v7, 55296, v5
    s_and_b32 s59, s36, 1
    s_mul_i32 s45, s59, 40960
    s_lshr_b32 s58, s36, 1
    s_lshl_b32 s58, s58, 12
    s_add_u32 s45, s45, s58
    s_lshr_b32 s58, s55, 1
    s_and_b32 s59, s55, 1
    s_lshl_b32 s59, s59, 1
    s_xor_b32 s58, s58, s59
    s_mov_b32 s6, 1985229328
    s_cmp_eq_u32 s58, 1
    s_cselect_b32 s6, 561402928, s6
    s_cmp_eq_u32 s58, 2
    s_cselect_b32 s6, 1126266448, s6
    s_cmp_eq_u32 s58, 3
    s_cselect_b32 s6, 1698898288, s6
    s_lshl_b32 s41, s37, 17
    s_lshl_b32 s42, s38, 8
    s_and_b32 s48, s6, 7
    s_mul_i32 s48, s48, 229376
    s_add_u32 s88, s48, s42
    s_mov_b32 s10, 2097152
    s_mov_b32 s11, 0x20000
    s_mov_b32 s14, 1835008
    s_mov_b32 s15, 0x20000
    s_mov_b32 s18, 1836032
    s_mov_b32 s19, 0x20000
    s_cmp_eq_u32 s56, 0
    s_cbranch_scc1 L_se
    s_bfe_u32 s46, s6, 196608
    s_lshl_b32 s46, s46, 7
    s_add_u32 m0, s7, 0
    s_add_u32 s46, s46, s41
    s_waitcnt lgkmcnt(0)
    s_sub_u32 s16, s16, 1024
    s_subb_u32 s17, s17, 0
    buffer_load_dwordx4 v1, s[8:11], s46 offen lds
    buffer_load_dwordx4 v2, s[8:11], s46 offen offset:1024 lds
    buffer_load_dwordx4 v3, s[8:11], s46 offen offset:2048 lds
    buffer_load_dwordx4 v4, s[8:11], s46 offen offset:3072 lds
    s_add_u32 m0, s45, 0
    s_nop 0
    buffer_load_dwordx4 v5, s[12:15], s88 offen lds
    buffer_load_dwordx4 v5, s[16:19], s88 offen offset:1024 lds
    buffer_load_dwordx4 v7, s[12:15], s88 offen offset:2048 lds
    buffer_load_dwordx4 v7, s[16:19], s88 offen offset:3072 lds
    s_branch L_main2
L_se:
    v_mov_b32 v247, v245
    s_waitcnt lgkmcnt(0)
    s_sub_u32 s16, s16, 1024
    s_subb_u32 s17, s17, 0
    s_bfe_u32 s46, s6, 196616
    s_lshl_b32 s58, s57, 2
    s_add_u32 s58, s58, s36
    s_lshr_b32 s59, s55, 1
    s_lshl_b32 s59, s59, 4
    s_add_u32 s59, s59, s58
    s_lshl_b32 s59, s59, 15
    s_lshl_b32 s47, s46, 7
    s_add_u32 s59, s59, s47
    v_lshlrev_b32 v244, 10, v0
    s_mov_b32 exec_hi, 0
    buffer_load_dword v253, v244, s[8:11], s59 offen
    s_mov_b64 exec, -1
    v_min_u32 v243, 55, v0
    v_mul_u32_u24 v244, 147, v243
    v_lshrrev_b32 v244, 11, v244
    v_mul_u32_u24 v245, 14, v244
    v_sub_u32 v245, v243, v245
    v_mul_u32_u24 v244, 3584, v244
    v_lshl_add_u32 v244, v245, 7, v244
    s_lshl_b32 s46, s46, 4
    s_add_u32 s58, s58, s46
    s_mul_i32 s58, s58, 14336
    s_and_b32 s59, s55, 1
    s_mul_i32 s59, s59, 1792
    s_add_u32 s58, s58, s59
    buffer_load_dword v251, v244, s[12:15], s58 offen
    buffer_load_dword v252, v244, s[16:19], s58 offen offset:1024
    v_mov_b32 v245, v247
    s_branch L_spare
L_main2:
    s_lshl_b32 s39, s55, 2
    s_add_u32 s39, s39, s57
    s_xor_b32 s40, s56, 3
    v_xor_b32 v6, 128, v5
    v_xor_b32 v8, 128, v7
    s_lshr_b32 s58, s36, 1
    s_lshl_b32 s58, s58, 17
    s_and_b32 s59, s36, 1
    s_lshl_b32 s59, s59, 15
    s_add_u32 s58, s58, s59
    v_lshlrev_b32 v246, 5, v242
    v_xor_b32 v246, v245, v246
    v_lshl_add_u32 v9, v240, 10, v246
    v_add_u32 v9, s58, v9
    v_add_u32 v10, 7168, v9
    v_add_u32 v11, 14336, v9
    v_add_u32 v12, 21504, v9
    s_mul_i32 s44, s36, 20480
    s_add_u32 s44, s44, 81920
    s_lshl_b32 s43, s40, 7
    s_mov_b32 s22, 1835008
    s_mov_b32 s23, 0x20000
    s_mov_b32 s26, 268435456
    s_mov_b32 s27, 0x20000
    s_mov_b32 s30, 2097152
    s_mov_b32 s31, 0x20000
    s_mov_b32 s34, 256
    s_mov_b32 s35, 0x20000
    s_bfe_u32 s58, s6, 196612
    s_mul_i32 s58, s58, 229376
    s_add_u32 s89, s58, s42
    s_bfe_u32 s58, s6, 196616
    s_mul_i32 s58, s58, 229376
    s_add_u32 s90, s58, s42
    s_bfe_u32 s58, s6, 196620
    s_mul_i32 s58, s58, 229376
    s_add_u32 s91, s58, s42
    s_bfe_u32 s58, s6, 196624
    s_mul_i32 s58, s58, 229376
    s_add_u32 s92, s58, s42
    s_bfe_u32 s58, s6, 196628
    s_mul_i32 s58, s58, 229376
    s_add_u32 s93, s58, s42
    s_bfe_u32 s58, s6, 196632
    s_mul_i32 s58, s58, 229376
    s_add_u32 s94, s58, s42
    s_bfe_u32 s58, s6, 196636
    s_mul_i32 s58, s58, 229376
    s_add_u32 s49, s58, s42
    v_lshrrev_b32 v240, 5, v0
    v_bfe_u32 v241, v0, 4, 1
    v_bfe_u32 v242, v0, 2, 2
    v_and_b32 v243, 3, v0
    v_bfe_u32 v244, v0, 3, 1
    v_lshlrev_b32 v243, 3, v243
    v_lshl_add_u32 v243, v242, 7, v243
    v_lshl_or_b32 v245, v241, 1, v244
    v_lshl_add_u32 v243, v245, 5, v243
    v_mul_u32_u24 v13, 40960, v241
    v_lshl_add_u32 v13, v240, 11, v13
    v_add_u32 v13, v13, v243
    s_and_b32 s58, s36, 1
    s_lshl_b32 s58, s58, 6
    v_xor_b32 v13, s58, v13
    v_xor_b32 v14, 32, v13
    v_lshrrev_b32 v246, 4, v0
    v_lshl_add_u32 v245, v246, 9, v243
    v_add_u32 v17, s44, v245
    v_xor_b32 v18, 32, v17
    v_xor_b32 v19, 64, v17
    v_xor_b32 v20, 96, v17
    v_and_b32 v245, 15, v0
    v_bfe_u32 v247, v0, 1, 3
    v_xor_b32 v247, v247, v246
    v_lshlrev_b32 v247, 4, v247
    v_lshl_add_u32 v245, v245, 7, v247
    s_lshr_b32 s58, s36, 1
    s_mul_i32 s58, s58, 40960
    s_add_u32 s58, s58, 81920
    v_add_u32 v15, s58, v245
    v_xor_b32 v16, 64, v15
    s_add_u32 s58, s39, s36
    v_lshlrev_b32 v21, 4, v0
    s_and_b32 s58, s58, 3
    s_cmp_eq_u32 s58, 3
    s_cselect_b32 s58, 4, s58
    s_lshl_b32 s58, s58, 7
    s_add_u32 s58, s58, 3712
    s_mov_b32 exec_lo, 0xff000000
    s_mov_b32 exec_hi, 0
    v_add_u32 v21, s58, v21
    s_mov_b64 exec, -1
    s_lshl_b32 s58, s36, 10
    v_add_u32 v21, s58, v21
    v_xor_b32 v22, 1024, v21
    v_xor_b32 v23, 2048, v21
    v_xor_b32 v24, 3072, v21
    s_mul_i32 s52, s39, 458752
    s_mul_i32 s58, s36, 114688
    s_add_u32 s52, s52, s58
    v_add_u32 v26, 5, v0
    v_lshrrev_b32 v26, 3, v26
    v_add_u32 v26, v26, v0
    v_min_u32 v26, 7, v26
    v_lshlrev_b32 v26, 7, v26
    s_lshl_b32 s58, s39, 13
    s_lshl_b32 s59, s36, 11
    s_add_u32 s58, s58, s59
    s_add_u32 s58, s58, 16777216
    v_add_u32 v26, s58, v26
    s_and_b32 s58, s57, 1
    s_lshl_b32 s58, s58, 2
    s_add_u32 s58, s58, s56
    s_sub_u32 s59, s58, 7
    s_cmp_ge_u32 s58, 7
    s_cselect_b32 s58, s59, s58
    s_lshl_b32 s59, s58, 18
    s_add_u32 s95, s59, s43
    s_add_u32 s58, s58, 1
    s_cmp_eq_u32 s58, 7
    s_cselect_b32 s58, 0, s58
    s_lshl_b32 s59, s58, 18
    s_add_u32 s96, s59, s43
    s_add_u32 s58, s58, 1
    s_cmp_eq_u32 s58, 7
    s_cselect_b32 s58, 0, s58
    s_lshl_b32 s59, s58, 18
    s_add_u32 s97, s59, s43
    s_add_u32 s58, s58, 1
    s_cmp_eq_u32 s58, 7
    s_cselect_b32 s58, 0, s58
    s_lshl_b32 s59, s58, 18
    s_add_u32 s98, s59, s43
    s_add_u32 s58, s58, 1
    s_cmp_eq_u32 s58, 7
    s_cselect_b32 s58, 0, s58
    s_lshl_b32 s59, s58, 18
    s_add_u32 s99, s59, s43
    s_add_u32 s58, s58, 1
    s_cmp_eq_u32 s58, 7
    s_cselect_b32 s58, 0, s58
    s_lshl_b32 s59, s58, 18
    s_add_u32 s100, s59, s43
    s_add_u32 s58, s58, 1
    s_cmp_eq_u32 s58, 7
    s_cselect_b32 s58, 0, s58
    s_lshl_b32 s59, s58, 18
    s_add_u32 s101, s59, s43
    s_lshl_b32 s58, s39, 16
    s_lshl_b32 s59, s36, 14
    s_add_u32 s58, s58, s59
    s_add_u32 s54, s58, s43
    s_lshr_b32 s58, s36, 1
    s_lshl_b32 s59, s37, 1
    s_add_u32 s58, s58, s59
    s_and_b32 s59, s38, 1
    s_lshl_b32 s59, s59, 1
    s_and_b32 s47, s36, 1
    s_add_u32 s59, s59, s47
    s_mul_i32 s50, s58, 458752
    s_mul_i32 s47, s59, 114688
    s_add_u32 s50, s50, s47
    s_lshr_b32 s48, s38, 1
    s_lshl_b32 s47, s48, 13
    s_add_u32 s50, s50, s47
    s_add_u32 s47, s58, s59
    v_lshlrev_b32 v25, 4, v0
    s_and_b32 s47, s47, 3
    s_cmp_eq_u32 s47, 3
    s_cselect_b32 s47, 4, s47
    s_lshl_b32 s47, s47, 7
    s_add_u32 s47, s47, 3712
    s_mov_b32 exec_lo, 0xff000000
    s_mov_b32 exec_hi, 0
    v_add_u32 v25, s47, v25
    s_mov_b64 exec, -1
    s_lshl_b32 s5, 1, s48
    s_mov_b32 s48, 0
    s_lshl_b32 s59, s59, 11
    s_add_u32 s59, s59, s48
    s_lshl_b32 s47, s58, 13
    s_add_u32 s59, s59, s47
    s_add_u32 s53, s59, 16777216
    s_lshl_b32 s58, s58, 2
    s_lshl_b32 s59, s39, 2
    v_mov_b32 v27, s58
    v_mov_b32 v240, s59
    v_cmp_lt_u32 vcc, 0, v0
    s_nop 1
    v_cndmask_b32 v27, v27, v240, vcc
    s_add_u32 m0, s45, 8192
    s_nop 0
    buffer_load_dwordx4 v6, s[12:15], s88 offen lds
    buffer_load_dwordx4 v6, s[16:19], s88 offen offset:1024 lds
    buffer_load_dwordx4 v8, s[12:15], s88 offen offset:2048 lds
    buffer_load_dwordx4 v8, s[16:19], s88 offen offset:3072 lds
    s_bfe_u32 s46, s6, 196612
    s_lshl_b32 s46, s46, 7
    s_add_u32 m0, s7, 4096
    s_add_u32 s46, s46, s41
    buffer_load_dwordx4 v1, s[8:11], s46 offen lds
    buffer_load_dwordx4 v2, s[8:11], s46 offen offset:1024 lds
    buffer_load_dwordx4 v3, s[8:11], s46 offen offset:2048 lds
    buffer_load_dwordx4 v4, s[8:11], s46 offen offset:3072 lds
    s_waitcnt vmcnt(8)
    s_barrier
    ds_read_b64_tr_b16 v[32:33], v13 offset:0
    ds_read_b128 a[0:3], v15 offset:0
    ds_read_b128 a[4:7], v15 offset:2048
    s_add_u32 m0, s45, 16384
    ds_read_b64_tr_b16 v[34:35], v13 offset:512
    ds_read_b128 a[8:11], v15 offset:20480
    ds_read_b128 a[12:15], v15 offset:22528
    ds_read_b128 a[16:19], v16 offset:0
    ds_read_b64_tr_b16 v[36:37], v13 offset:1024
    ds_read_b128 a[20:23], v16 offset:2048
    buffer_load_dwordx4 v5, s[12:15], s89 offen lds
    ds_read_b128 a[24:27], v16 offset:20480
    ds_read_b128 a[28:31], v16 offset:22528
    ds_read_b64_tr_b16 v[38:39], v13 offset:1536
    buffer_load_dwordx4 v5, s[16:19], s89 offen offset:1024 lds
    ds_read_b64_tr_b16 v[40:41], v14 offset:0
    buffer_load_dwordx4 v7, s[12:15], s89 offen offset:2048 lds
    ds_read_b64_tr_b16 v[42:43], v14 offset:512
    s_waitcnt lgkmcnt(12)
    ds_read_b64_tr_b16 v[44:45], v14 offset:1024
    buffer_load_dwordx4 v7, s[16:19], s89 offen offset:3072 lds
    ds_read_b64_tr_b16 v[46:47], v14 offset:1536
    s_add_u32 m0, s45, 24576
    s_waitcnt lgkmcnt(4)
    v_mfma_f32_16x16x32_bf16 v[64:67], v[32:35], a[0:3], 0
    ds_read_b64_tr_b16 v[48:49], v13 offset:4096
    v_mfma_f32_16x16x32_bf16 v[68:71], v[32:35], a[4:7], 0
    v_mfma_f32_16x16x32_bf16 v[72:75], v[32:35], a[8:11], 0
    ds_read_b64_tr_b16 v[50:51], v13 offset:4608
    v_mfma_f32_16x16x32_bf16 v[76:79], v[32:35], a[12:15], 0
    buffer_load_dwordx4 v6, s[12:15], s89 offen lds
    v_mfma_f32_16x16x32_bf16 v[80:83], v[36:39], a[0:3], 0
    ds_read_b64_tr_b16 v[52:53], v13 offset:5120
    v_mfma_f32_16x16x32_bf16 v[84:87], v[36:39], a[4:7], 0
    v_mfma_f32_16x16x32_bf16 v[88:91], v[36:39], a[8:11], 0
    ds_read_b64_tr_b16 v[54:55], v13 offset:5632
    v_mfma_f32_16x16x32_bf16 v[92:95], v[36:39], a[12:15], 0
    s_waitcnt lgkmcnt(4)
    v_mfma_f32_16x16x32_bf16 v[96:99], v[40:43], a[0:3], 0
    ds_read_b64_tr_b16 v[56:57], v14 offset:4096
    v_mfma_f32_16x16x32_bf16 v[100:103], v[40:43], a[4:7], 0
    buffer_load_dwordx4 v6, s[16:19], s89 offen offset:1024 lds
    v_mfma_f32_16x16x32_bf16 v[104:107], v[40:43], a[8:11], 0
    ds_read_b64_tr_b16 v[58:59], v14 offset:4608
    v_mfma_f32_16x16x32_bf16 v[108:111], v[40:43], a[12:15], 0
    buffer_load_dwordx4 v8, s[12:15], s89 offen offset:2048 lds
    v_mfma_f32_16x16x32_bf16 v[112:115], v[44:47], a[0:3], 0
    ds_read_b64_tr_b16 v[60:61], v14 offset:5120
    v_mfma_f32_16x16x32_bf16 v[116:119], v[44:47], a[4:7], 0
    v_mfma_f32_16x16x32_bf16 v[120:123], v[44:47], a[8:11], 0
    ds_read_b64_tr_b16 v[62:63], v14 offset:5632
    v_mfma_f32_16x16x32_bf16 v[124:127], v[44:47], a[12:15], 0
    s_waitcnt vmcnt(11)
    s_barrier
    s_waitcnt lgkmcnt(4)
    v_mfma_f32_16x16x32_bf16 v[64:67], v[48:51], a[16:19], v[64:67]
    ds_read_b64_tr_b16 v[32:33], v13 offset:8192
    v_mfma_f32_16x16x32_bf16 v[68:71], v[48:51], a[20:23], v[68:71]
    buffer_load_dwordx4 v8, s[16:19], s89 offen offset:3072 lds
    v_mfma_f32_16x16x32_bf16 v[72:75], v[48:51], a[24:27], v[72:75]
    ds_read_b64_tr_b16 v[34:35], v13 offset:8704
    s_bfe_u32 s46, s6, 196616
    v_mfma_f32_16x16x32_bf16 v[76:79], v[48:51], a[28:31], v[76:79]
    s_lshl_b32 s46, s46, 7
    s_add_u32 m0, s7, 8192
    v_mfma_f32_16x16x32_bf16 v[80:83], v[52:55], a[16:19], v[80:83]
    ds_read_b64_tr_b16 v[36:37], v13 offset:9216
    s_add_u32 s46, s46, s41
    v_mfma_f32_16x16x32_bf16 v[84:87], v[52:55], a[20:23], v[84:87]
    buffer_load_dwordx4 v1, s[8:11], s46 offen lds
    v_mfma_f32_16x16x32_bf16 v[88:91], v[52:55], a[24:27], v[88:91]
    ds_read_b64_tr_b16 v[38:39], v13 offset:9728
    v_mfma_f32_16x16x32_bf16 v[92:95], v[52:55], a[28:31], v[92:95]
    s_waitcnt lgkmcnt(4)
    v_mfma_f32_16x16x32_bf16 v[96:99], v[56:59], a[16:19], v[96:99]
    ds_read_b64_tr_b16 v[40:41], v14 offset:8192
    v_mfma_f32_16x16x32_bf16 v[100:103], v[56:59], a[20:23], v[100:103]
    buffer_load_dwordx4 v2, s[8:11], s46 offen offset:1024 lds
    v_mfma_f32_16x16x32_bf16 v[104:107], v[56:59], a[24:27], v[104:107]
    ds_read_b64_tr_b16 v[42:43], v14 offset:8704
    v_mfma_f32_16x16x32_bf16 v[108:111], v[56:59], a[28:31], v[108:111]
    v_mfma_f32_16x16x32_bf16 v[112:115], v[60:63], a[16:19], v[112:115]
    ds_read_b64_tr_b16 v[44:45], v14 offset:9216
    v_mfma_f32_16x16x32_bf16 v[116:119], v[60:63], a[20:23], v[116:119]
    buffer_load_dwordx4 v3, s[8:11], s46 offen offset:2048 lds
    v_mfma_f32_16x16x32_bf16 v[120:123], v[60:63], a[24:27], v[120:123]
    ds_read_b64_tr_b16 v[46:47], v14 offset:9728
    v_mfma_f32_16x16x32_bf16 v[124:127], v[60:63], a[28:31], v[124:127]
    s_waitcnt lgkmcnt(4)
    v_mfma_f32_16x16x32_bf16 v[128:131], v[32:35], a[0:3], 0
    ds_read_b64_tr_b16 v[48:49], v13 offset:12288
    v_mfma_f32_16x16x32_bf16 v[132:135], v[32:35], a[4:7], 0
    v_mfma_f32_16x16x32_bf16 v[136:139], v[32:35], a[8:11], 0
    ds_read_b64_tr_b16 v[50:51], v13 offset:12800
    v_mfma_f32_16x16x32_bf16 v[140:143], v[32:35], a[12:15], 0
    buffer_load_dwordx4 v4, s[8:11], s46 offen offset:3072 lds
    v_mfma_f32_16x16x32_bf16 v[144:147], v[36:39], a[0:3], 0
    ds_read_b64_tr_b16 v[52:53], v13 offset:13312
    s_add_u32 m0, s45, 32768
    v_mfma_f32_16x16x32_bf16 v[148:151], v[36:39], a[4:7], 0
    v_mfma_f32_16x16x32_bf16 v[152:155], v[36:39], a[8:11], 0
    ds_read_b64_tr_b16 v[54:55], v13 offset:13824
    v_mfma_f32_16x16x32_bf16 v[156:159], v[36:39], a[12:15], 0
    s_waitcnt lgkmcnt(4)
    v_mfma_f32_16x16x32_bf16 v[160:163], v[40:43], a[0:3], 0
    ds_read_b64_tr_b16 v[56:57], v14 offset:12288
    v_mfma_f32_16x16x32_bf16 v[164:167], v[40:43], a[4:7], 0
    buffer_load_dwordx4 v5, s[12:15], s90 offen lds
    v_mfma_f32_16x16x32_bf16 v[168:171], v[40:43], a[8:11], 0
    ds_read_b64_tr_b16 v[58:59], v14 offset:12800
    v_mfma_f32_16x16x32_bf16 v[172:175], v[40:43], a[12:15], 0
    buffer_load_dwordx4 v5, s[16:19], s90 offen offset:1024 lds
    v_mfma_f32_16x16x32_bf16 v[176:179], v[44:47], a[0:3], 0
    ds_read_b64_tr_b16 v[60:61], v14 offset:13312
    v_mfma_f32_16x16x32_bf16 v[180:183], v[44:47], a[4:7], 0
    v_mfma_f32_16x16x32_bf16 v[184:187], v[44:47], a[8:11], 0
    ds_read_b64_tr_b16 v[62:63], v14 offset:13824
    v_mfma_f32_16x16x32_bf16 v[188:191], v[44:47], a[12:15], 0
    s_waitcnt vmcnt(10)
    s_barrier
    s_waitcnt lgkmcnt(4)
    v_mfma_f32_16x16x32_bf16 v[128:131], v[48:51], a[16:19], v[128:131]
    ds_read_b64_tr_b16 v[32:33], v13 offset:16384
    ds_read_b128 a[32:35], v15 offset:4096
    v_mfma_f32_16x16x32_bf16 v[132:135], v[48:51], a[20:23], v[132:135]
    ds_read_b128 a[36:39], v15 offset:6144
    ds_read_b128 a[40:43], v15 offset:24576
    v_mfma_f32_16x16x32_bf16 v[136:139], v[48:51], a[24:27], v[136:139]
    ds_read_b64_tr_b16 v[34:35], v13 offset:16896
    ds_read_b128 a[44:47], v15 offset:26624
    v_mfma_f32_16x16x32_bf16 v[140:143], v[48:51], a[28:31], v[140:143]
    ds_read_b128 a[48:51], v16 offset:4096
    ds_read_b128 a[52:55], v16 offset:6144
    v_mfma_f32_16x16x32_bf16 v[144:147], v[52:55], a[16:19], v[144:147]
    ds_read_b64_tr_b16 v[36:37], v13 offset:17408
    ds_read_b128 a[56:59], v16 offset:24576
    buffer_load_dwordx4 v7, s[12:15], s90 offen offset:2048 lds
    v_mfma_f32_16x16x32_bf16 v[148:151], v[52:55], a[20:23], v[148:151]
    s_waitcnt lgkmcnt(12)
    ds_read_b128 a[60:63], v16 offset:26624
    v_mfma_f32_16x16x32_bf16 v[152:155], v[52:55], a[24:27], v[152:155]
    ds_read_b64_tr_b16 v[38:39], v13 offset:17920
    v_mfma_f32_16x16x32_bf16 v[156:159], v[52:55], a[28:31], v[156:159]
    buffer_load_dwordx4 v7, s[16:19], s90 offen offset:3072 lds
    s_waitcnt lgkmcnt(12)
    v_mfma_f32_16x16x32_bf16 v[160:163], v[56:59], a[16:19], v[160:163]
    ds_read_b64_tr_b16 v[40:41], v14 offset:16384
    s_bfe_u32 s46, s6, 196620
    v_mfma_f32_16x16x32_bf16 v[164:167], v[56:59], a[20:23], v[164:167]
    s_lshl_b32 s46, s46, 7
    s_add_u32 m0, s7, 0
    v_mfma_f32_16x16x32_bf16 v[168:171], v[56:59], a[24:27], v[168:171]
    ds_read_b64_tr_b16 v[42:43], v14 offset:16896
    s_add_u32 s46, s46, s41
    v_mfma_f32_16x16x32_bf16 v[172:175], v[56:59], a[28:31], v[172:175]
    buffer_load_dwordx4 v1, s[8:11], s46 offen lds
    v_mfma_f32_16x16x32_bf16 v[176:179], v[60:63], a[16:19], v[176:179]
    s_waitcnt lgkmcnt(12)
    ds_read_b64_tr_b16 v[44:45], v14 offset:17408
    v_mfma_f32_16x16x32_bf16 v[180:183], v[60:63], a[20:23], v[180:183]
    buffer_load_dwordx4 v2, s[8:11], s46 offen offset:1024 lds
    v_mfma_f32_16x16x32_bf16 v[184:187], v[60:63], a[24:27], v[184:187]
    ds_read_b64_tr_b16 v[46:47], v14 offset:17920
    v_mfma_f32_16x16x32_bf16 v[188:191], v[60:63], a[28:31], v[188:191]
    s_waitcnt lgkmcnt(4)
    v_mfma_f32_16x16x32_bf16 v[64:67], v[32:35], a[32:35], v[64:67]
    ds_read_b64_tr_b16 v[48:49], v13 offset:20480
    v_mfma_f32_16x16x32_bf16 v[68:71], v[32:35], a[36:39], v[68:71]
    v_mfma_f32_16x16x32_bf16 v[72:75], v[32:35], a[40:43], v[72:75]
    ds_read_b64_tr_b16 v[50:51], v13 offset:20992
    v_mfma_f32_16x16x32_bf16 v[76:79], v[32:35], a[44:47], v[76:79]
    buffer_load_dwordx4 v3, s[8:11], s46 offen offset:2048 lds
    v_mfma_f32_16x16x32_bf16 v[80:83], v[36:39], a[32:35], v[80:83]
    ds_read_b64_tr_b16 v[52:53], v13 offset:21504
    v_mfma_f32_16x16x32_bf16 v[84:87], v[36:39], a[36:39], v[84:87]
    v_mfma_f32_16x16x32_bf16 v[88:91], v[36:39], a[40:43], v[88:91]
    ds_read_b64_tr_b16 v[54:55], v13 offset:22016
    v_mfma_f32_16x16x32_bf16 v[92:95], v[36:39], a[44:47], v[92:95]
    s_waitcnt lgkmcnt(4)
    v_mfma_f32_16x16x32_bf16 v[96:99], v[40:43], a[32:35], v[96:99]
    ds_read_b64_tr_b16 v[56:57], v14 offset:20480
    v_mfma_f32_16x16x32_bf16 v[100:103], v[40:43], a[36:39], v[100:103]
    buffer_load_dwordx4 v4, s[8:11], s46 offen offset:3072 lds
    v_mfma_f32_16x16x32_bf16 v[104:107], v[40:43], a[40:43], v[104:107]
    ds_read_b64_tr_b16 v[58:59], v14 offset:20992
    s_add_u32 m0, s45, 0
    v_mfma_f32_16x16x32_bf16 v[108:111], v[40:43], a[44:47], v[108:111]
    buffer_load_dwordx4 v5, s[12:15], s91 offen lds
    v_mfma_f32_16x16x32_bf16 v[112:115], v[44:47], a[32:35], v[112:115]
    ds_read_b64_tr_b16 v[60:61], v14 offset:21504
    v_mfma_f32_16x16x32_bf16 v[116:119], v[44:47], a[36:39], v[116:119]
    v_mfma_f32_16x16x32_bf16 v[120:123], v[44:47], a[40:43], v[120:123]
    ds_read_b64_tr_b16 v[62:63], v14 offset:22016
    v_mfma_f32_16x16x32_bf16 v[124:127], v[44:47], a[44:47], v[124:127]
    s_waitcnt vmcnt(13)
    s_barrier
    s_waitcnt lgkmcnt(4)
    v_mfma_f32_16x16x32_bf16 v[64:67], v[48:51], a[48:51], v[64:67]
    ds_read_b64_tr_b16 v[32:33], v13 offset:24576
    v_mfma_f32_16x16x32_bf16 v[68:71], v[48:51], a[52:55], v[68:71]
    buffer_load_dwordx4 v5, s[16:19], s91 offen offset:1024 lds
    v_mfma_f32_16x16x32_bf16 v[72:75], v[48:51], a[56:59], v[72:75]
    ds_read_b64_tr_b16 v[34:35], v13 offset:25088
    v_mfma_f32_16x16x32_bf16 v[76:79], v[48:51], a[60:63], v[76:79]
    v_mfma_f32_16x16x32_bf16 v[80:83], v[52:55], a[48:51], v[80:83]
    ds_read_b64_tr_b16 v[36:37], v13 offset:25600
    v_mfma_f32_16x16x32_bf16 v[84:87], v[52:55], a[52:55], v[84:87]
    buffer_load_dwordx4 v7, s[12:15], s91 offen offset:2048 lds
    v_mfma_f32_16x16x32_bf16 v[88:91], v[52:55], a[56:59], v[88:91]
    ds_read_b64_tr_b16 v[38:39], v13 offset:26112
    v_mfma_f32_16x16x32_bf16 v[92:95], v[52:55], a[60:63], v[92:95]
    s_waitcnt lgkmcnt(4)
    v_mfma_f32_16x16x32_bf16 v[96:99], v[56:59], a[48:51], v[96:99]
    ds_read_b64_tr_b16 v[40:41], v14 offset:24576
    v_mfma_f32_16x16x32_bf16 v[100:103], v[56:59], a[52:55], v[100:103]
    buffer_load_dwordx4 v7, s[16:19], s91 offen offset:3072 lds
    v_mfma_f32_16x16x32_bf16 v[104:107], v[56:59], a[56:59], v[104:107]
    ds_read_b64_tr_b16 v[42:43], v14 offset:25088
    s_add_u32 m0, s45, 8192
    v_mfma_f32_16x16x32_bf16 v[108:111], v[56:59], a[60:63], v[108:111]
    v_mfma_f32_16x16x32_bf16 v[112:115], v[60:63], a[48:51], v[112:115]
    ds_read_b64_tr_b16 v[44:45], v14 offset:25600
    v_mfma_f32_16x16x32_bf16 v[116:119], v[60:63], a[52:55], v[116:119]
    buffer_load_dwordx4 v6, s[12:15], s90 offen lds
    v_mfma_f32_16x16x32_bf16 v[120:123], v[60:63], a[56:59], v[120:123]
    ds_read_b64_tr_b16 v[46:47], v14 offset:26112
    v_mfma_f32_16x16x32_bf16 v[124:127], v[60:63], a[60:63], v[124:127]
    s_waitcnt lgkmcnt(4)
    v_mfma_f32_16x16x32_bf16 v[128:131], v[32:35], a[32:35], v[128:131]
    ds_read_b64_tr_b16 v[48:49], v13 offset:28672
    v_mfma_f32_16x16x32_bf16 v[132:135], v[32:35], a[36:39], v[132:135]
    buffer_load_dwordx4 v6, s[16:19], s90 offen offset:1024 lds
    v_mfma_f32_16x16x32_bf16 v[136:139], v[32:35], a[40:43], v[136:139]
    ds_read_b64_tr_b16 v[50:51], v13 offset:29184
    v_mfma_f32_16x16x32_bf16 v[140:143], v[32:35], a[44:47], v[140:143]
    v_mfma_f32_16x16x32_bf16 v[144:147], v[36:39], a[32:35], v[144:147]
    ds_read_b64_tr_b16 v[52:53], v13 offset:29696
    v_mfma_f32_16x16x32_bf16 v[148:151], v[36:39], a[36:39], v[148:151]
    buffer_load_dwordx4 v8, s[12:15], s90 offen offset:2048 lds
    v_mfma_f32_16x16x32_bf16 v[152:155], v[36:39], a[40:43], v[152:155]
    ds_read_b64_tr_b16 v[54:55], v13 offset:30208
    v_mfma_f32_16x16x32_bf16 v[156:159], v[36:39], a[44:47], v[156:159]
    s_waitcnt lgkmcnt(4)
    v_mfma_f32_16x16x32_bf16 v[160:163], v[40:43], a[32:35], v[160:163]
    ds_read_b64_tr_b16 v[56:57], v14 offset:28672
    v_mfma_f32_16x16x32_bf16 v[164:167], v[40:43], a[36:39], v[164:167]
    buffer_load_dwordx4 v8, s[16:19], s90 offen offset:3072 lds
    v_mfma_f32_16x16x32_bf16 v[168:171], v[40:43], a[40:43], v[168:171]
    ds_read_b64_tr_b16 v[58:59], v14 offset:29184
    s_bfe_u32 s46, s6, 196624
    v_mfma_f32_16x16x32_bf16 v[172:175], v[40:43], a[44:47], v[172:175]
    s_lshl_b32 s46, s46, 7
    s_add_u32 m0, s7, 4096
    v_mfma_f32_16x16x32_bf16 v[176:179], v[44:47], a[32:35], v[176:179]
    ds_read_b64_tr_b16 v[60:61], v14 offset:29696
    s_add_u32 s46, s46, s41
    v_mfma_f32_16x16x32_bf16 v[180:183], v[44:47], a[36:39], v[180:183]
    buffer_load_dwordx4 v1, s[8:11], s46 offen lds
    v_mfma_f32_16x16x32_bf16 v[184:187], v[44:47], a[40:43], v[184:187]
    ds_read_b64_tr_b16 v[62:63], v14 offset:30208
    v_mfma_f32_16x16x32_bf16 v[188:191], v[44:47], a[44:47], v[188:191]
    s_waitcnt vmcnt(13)
    s_barrier
    s_waitcnt lgkmcnt(4)
    v_mfma_f32_16x16x32_bf16 v[128:131], v[48:51], a[48:51], v[128:131]
    ds_read_b64_tr_b16 v[32:33], v13 offset:32768
    ds_read_b128 a[64:67], v15 offset:8192
    v_mfma_f32_16x16x32_bf16 v[132:135], v[48:51], a[52:55], v[132:135]
    ds_read_b128 a[68:71], v15 offset:10240
    ds_read_b128 a[72:75], v15 offset:28672
    v_mfma_f32_16x16x32_bf16 v[136:139], v[48:51], a[56:59], v[136:139]
    ds_read_b64_tr_b16 v[34:35], v13 offset:33280
    ds_read_b128 a[76:79], v15 offset:30720
    v_mfma_f32_16x16x32_bf16 v[140:143], v[48:51], a[60:63], v[140:143]
    ds_read_b128 a[80:83], v16 offset:8192
    ds_read_b128 a[84:87], v16 offset:10240
    v_mfma_f32_16x16x32_bf16 v[144:147], v[52:55], a[48:51], v[144:147]
    ds_read_b64_tr_b16 v[36:37], v13 offset:33792
    ds_read_b128 a[88:91], v16 offset:28672
    buffer_load_dwordx4 v2, s[8:11], s46 offen offset:1024 lds
    v_mfma_f32_16x16x32_bf16 v[148:151], v[52:55], a[52:55], v[148:151]
    s_waitcnt lgkmcnt(12)
    ds_read_b128 a[92:95], v16 offset:30720
    v_mfma_f32_16x16x32_bf16 v[152:155], v[52:55], a[56:59], v[152:155]
    ds_read_b64_tr_b16 v[38:39], v13 offset:34304
    v_mfma_f32_16x16x32_bf16 v[156:159], v[52:55], a[60:63], v[156:159]
    buffer_load_dwordx4 v3, s[8:11], s46 offen offset:2048 lds
    s_waitcnt lgkmcnt(12)
    v_mfma_f32_16x16x32_bf16 v[160:163], v[56:59], a[48:51], v[160:163]
    ds_read_b64_tr_b16 v[40:41], v14 offset:32768
    v_mfma_f32_16x16x32_bf16 v[164:167], v[56:59], a[52:55], v[164:167]
    buffer_load_dwordx4 v4, s[8:11], s46 offen offset:3072 lds
    v_mfma_f32_16x16x32_bf16 v[168:171], v[56:59], a[56:59], v[168:171]
    ds_read_b64_tr_b16 v[42:43], v14 offset:33280
    s_add_u32 m0, s44, 12288
    v_mfma_f32_16x16x32_bf16 v[172:175], v[56:59], a[60:63], v[172:175]
    v_mfma_f32_16x16x32_bf16 v[176:179], v[60:63], a[48:51], v[176:179]
    s_waitcnt lgkmcnt(12)
    ds_read_b64_tr_b16 v[44:45], v14 offset:33792
    v_mfma_f32_16x16x32_bf16 v[180:183], v[60:63], a[52:55], v[180:183]
    buffer_load_dwordx4 v9, s[20:23], s95 offen lds
    v_mfma_f32_16x16x32_bf16 v[184:187], v[60:63], a[56:59], v[184:187]
    ds_read_b64_tr_b16 v[46:47], v14 offset:34304
    v_mfma_f32_16x16x32_bf16 v[188:191], v[60:63], a[60:63], v[188:191]
    s_waitcnt lgkmcnt(4)
    v_mfma_f32_16x16x32_bf16 v[64:67], v[32:35], a[64:67], v[64:67]
    ds_read_b64_tr_b16 v[48:49], v13 offset:36864
    v_mfma_f32_16x16x32_bf16 v[68:71], v[32:35], a[68:71], v[68:71]
    buffer_load_dwordx4 v10, s[20:23], s95 offen offset:1024 lds
    v_mfma_f32_16x16x32_bf16 v[72:75], v[32:35], a[72:75], v[72:75]
    ds_read_b64_tr_b16 v[50:51], v13 offset:37376
    v_mfma_f32_16x16x32_bf16 v[76:79], v[32:35], a[76:79], v[76:79]
    v_mfma_f32_16x16x32_bf16 v[80:83], v[36:39], a[64:67], v[80:83]
    ds_read_b64_tr_b16 v[52:53], v13 offset:37888
    v_mfma_f32_16x16x32_bf16 v[84:87], v[36:39], a[68:71], v[84:87]
    buffer_load_dwordx4 v11, s[20:23], s95 offen offset:2048 lds
    v_mfma_f32_16x16x32_bf16 v[88:91], v[36:39], a[72:75], v[88:91]
    ds_read_b64_tr_b16 v[54:55], v13 offset:38400
    v_mfma_f32_16x16x32_bf16 v[92:95], v[36:39], a[76:79], v[92:95]
    s_waitcnt lgkmcnt(4)
    v_mfma_f32_16x16x32_bf16 v[96:99], v[40:43], a[64:67], v[96:99]
    ds_read_b64_tr_b16 v[56:57], v14 offset:36864
    v_mfma_f32_16x16x32_bf16 v[100:103], v[40:43], a[68:71], v[100:103]
    buffer_load_dwordx4 v12, s[20:23], s95 offen offset:3072 lds
    v_mfma_f32_16x16x32_bf16 v[104:107], v[40:43], a[72:75], v[104:107]
    ds_read_b64_tr_b16 v[58:59], v14 offset:37376
    s_add_u32 m0, s45, 16384
    v_mfma_f32_16x16x32_bf16 v[108:111], v[40:43], a[76:79], v[108:111]
    v_mfma_f32_16x16x32_bf16 v[112:115], v[44:47], a[64:67], v[112:115]
    ds_read_b64_tr_b16 v[60:61], v14 offset:37888
    v_mfma_f32_16x16x32_bf16 v[116:119], v[44:47], a[68:71], v[116:119]
    buffer_load_dwordx4 v5, s[12:15], s92 offen lds
    v_mfma_f32_16x16x32_bf16 v[120:123], v[44:47], a[72:75], v[120:123]
    ds_read_b64_tr_b16 v[62:63], v14 offset:38400
    v_mfma_f32_16x16x32_bf16 v[124:127], v[44:47], a[76:79], v[124:127]
    s_waitcnt vmcnt(13)
    s_barrier
    s_waitcnt lgkmcnt(4)
    v_mfma_f32_16x16x32_bf16 v[64:67], v[48:51], a[80:83], v[64:67]
    ds_read_b64_tr_b16 v[32:33], v13 offset:0
    ds_read_b128 a[96:99], v15 offset:0
    v_mfma_f32_16x16x32_bf16 v[68:71], v[48:51], a[84:87], v[68:71]
    ds_read_b128 a[100:103], v15 offset:2048
    ds_read_b128 a[104:107], v15 offset:20480
    v_mfma_f32_16x16x32_bf16 v[72:75], v[48:51], a[88:91], v[72:75]
    ds_read_b64_tr_b16 v[34:35], v13 offset:512
    ds_read_b128 a[108:111], v15 offset:22528
    v_mfma_f32_16x16x32_bf16 v[76:79], v[48:51], a[92:95], v[76:79]
    ds_read_b128 a[112:115], v16 offset:0
    ds_read_b128 a[116:119], v16 offset:2048
    v_mfma_f32_16x16x32_bf16 v[80:83], v[52:55], a[80:83], v[80:83]
    ds_read_b64_tr_b16 v[36:37], v13 offset:1024
    ds_read_b128 a[120:123], v16 offset:20480
    buffer_load_dwordx4 v5, s[16:19], s92 offen offset:1024 lds
    v_mfma_f32_16x16x32_bf16 v[84:87], v[52:55], a[84:87], v[84:87]
    s_waitcnt lgkmcnt(12)
    ds_read_b128 a[124:127], v16 offset:22528
    v_mfma_f32_16x16x32_bf16 v[88:91], v[52:55], a[88:91], v[88:91]
    ds_read_b64_tr_b16 v[38:39], v13 offset:1536
    v_mfma_f32_16x16x32_bf16 v[92:95], v[52:55], a[92:95], v[92:95]
    buffer_load_dwordx4 v7, s[12:15], s92 offen offset:2048 lds
    s_waitcnt lgkmcnt(12)
    v_mfma_f32_16x16x32_bf16 v[96:99], v[56:59], a[80:83], v[96:99]
    ds_read_b64_tr_b16 v[40:41], v14 offset:0
    v_mfma_f32_16x16x32_bf16 v[100:103], v[56:59], a[84:87], v[100:103]
    buffer_load_dwordx4 v7, s[16:19], s92 offen offset:3072 lds
    v_mfma_f32_16x16x32_bf16 v[104:107], v[56:59], a[88:91], v[104:107]
    ds_read_b64_tr_b16 v[42:43], v14 offset:512
    s_add_u32 m0, s44, 16384
    v_mfma_f32_16x16x32_bf16 v[108:111], v[56:59], a[92:95], v[108:111]
    v_mfma_f32_16x16x32_bf16 v[112:115], v[60:63], a[80:83], v[112:115]
    s_waitcnt lgkmcnt(12)
    ds_read_b64_tr_b16 v[44:45], v14 offset:1024
    v_mfma_f32_16x16x32_bf16 v[116:119], v[60:63], a[84:87], v[116:119]
    buffer_load_dwordx4 v9, s[20:23], s96 offen lds
    v_mfma_f32_16x16x32_bf16 v[120:123], v[60:63], a[88:91], v[120:123]
    ds_read_b64_tr_b16 v[46:47], v14 offset:1536
    v_mfma_f32_16x16x32_bf16 v[124:127], v[60:63], a[92:95], v[124:127]
    s_waitcnt lgkmcnt(4)
    v_mfma_f32_16x16x32_bf16 v[64:67], v[32:35], a[96:99], v[64:67]
    ds_read_b64_tr_b16 v[48:49], v13 offset:4096
    v_mfma_f32_16x16x32_bf16 v[68:71], v[32:35], a[100:103], v[68:71]
    buffer_load_dwordx4 v10, s[20:23], s96 offen offset:1024 lds
    v_mfma_f32_16x16x32_bf16 v[72:75], v[32:35], a[104:107], v[72:75]
    ds_read_b64_tr_b16 v[50:51], v13 offset:4608
    v_mfma_f32_16x16x32_bf16 v[76:79], v[32:35], a[108:111], v[76:79]
    v_mfma_f32_16x16x32_bf16 v[80:83], v[36:39], a[96:99], v[80:83]
    ds_read_b64_tr_b16 v[52:53], v13 offset:5120
    v_mfma_f32_16x16x32_bf16 v[84:87], v[36:39], a[100:103], v[84:87]
    buffer_load_dwordx4 v11, s[20:23], s96 offen offset:2048 lds
    v_mfma_f32_16x16x32_bf16 v[88:91], v[36:39], a[104:107], v[88:91]
    ds_read_b64_tr_b16 v[54:55], v13 offset:5632
    v_mfma_f32_16x16x32_bf16 v[92:95], v[36:39], a[108:111], v[92:95]
    s_waitcnt lgkmcnt(4)
    v_mfma_f32_16x16x32_bf16 v[96:99], v[40:43], a[96:99], v[96:99]
    ds_read_b64_tr_b16 v[56:57], v14 offset:4096
    v_mfma_f32_16x16x32_bf16 v[100:103], v[40:43], a[100:103], v[100:103]
    buffer_load_dwordx4 v12, s[20:23], s96 offen offset:3072 lds
    v_mfma_f32_16x16x32_bf16 v[104:107], v[40:43], a[104:107], v[104:107]
    ds_read_b64_tr_b16 v[58:59], v14 offset:4608
    s_add_u32 m0, s45, 24576
    v_mfma_f32_16x16x32_bf16 v[108:111], v[40:43], a[108:111], v[108:111]
    v_mfma_f32_16x16x32_bf16 v[112:115], v[44:47], a[96:99], v[112:115]
    ds_read_b64_tr_b16 v[60:61], v14 offset:5120
    v_mfma_f32_16x16x32_bf16 v[116:119], v[44:47], a[100:103], v[116:119]
    buffer_load_dwordx4 v6, s[12:15], s91 offen lds
    v_mfma_f32_16x16x32_bf16 v[120:123], v[44:47], a[104:107], v[120:123]
    ds_read_b64_tr_b16 v[62:63], v14 offset:5632
    v_mfma_f32_16x16x32_bf16 v[124:127], v[44:47], a[108:111], v[124:127]
    s_waitcnt vmcnt(17)
    s_barrier
    s_waitcnt lgkmcnt(4)
    v_mfma_f32_16x16x32_bf16 v[64:67], v[48:51], a[112:115], v[64:67]
    ds_read_b64_tr_b16 v[32:33], v13 offset:8192
    v_mfma_f32_16x16x32_bf16 v[68:71], v[48:51], a[116:119], v[68:71]
    buffer_load_dwordx4 v6, s[16:19], s91 offen offset:1024 lds
    v_mfma_f32_16x16x32_bf16 v[72:75], v[48:51], a[120:123], v[72:75]
    ds_read_b64_tr_b16 v[34:35], v13 offset:8704
    v_mfma_f32_16x16x32_bf16 v[76:79], v[48:51], a[124:127], v[76:79]
    v_mfma_f32_16x16x32_bf16 v[80:83], v[52:55], a[112:115], v[80:83]
    ds_read_b64_tr_b16 v[36:37], v13 offset:9216
    v_mfma_f32_16x16x32_bf16 v[84:87], v[52:55], a[116:119], v[84:87]
    buffer_load_dwordx4 v8, s[12:15], s91 offen offset:2048 lds
    v_mfma_f32_16x16x32_bf16 v[88:91], v[52:55], a[120:123], v[88:91]
    ds_read_b64_tr_b16 v[38:39], v13 offset:9728
    v_mfma_f32_16x16x32_bf16 v[92:95], v[52:55], a[124:127], v[92:95]
    s_waitcnt lgkmcnt(4)
    v_mfma_f32_16x16x32_bf16 v[96:99], v[56:59], a[112:115], v[96:99]
    ds_read_b64_tr_b16 v[40:41], v14 offset:8192
    v_mfma_f32_16x16x32_bf16 v[100:103], v[56:59], a[116:119], v[100:103]
    buffer_load_dwordx4 v8, s[16:19], s91 offen offset:3072 lds
    v_mfma_f32_16x16x32_bf16 v[104:107], v[56:59], a[120:123], v[104:107]
    ds_read_b64_tr_b16 v[42:43], v14 offset:8704
    s_bfe_u32 s46, s6, 196628
    v_mfma_f32_16x16x32_bf16 v[108:111], v[56:59], a[124:127], v[108:111]
    s_lshl_b32 s46, s46, 7
    s_add_u32 m0, s7, 8192
    v_mfma_f32_16x16x32_bf16 v[112:115], v[60:63], a[112:115], v[112:115]
    ds_read_b64_tr_b16 v[44:45], v14 offset:9216
    s_add_u32 s46, s46, s41
    v_mfma_f32_16x16x32_bf16 v[116:119], v[60:63], a[116:119], v[116:119]
    buffer_load_dwordx4 v1, s[8:11], s46 offen lds
    v_mfma_f32_16x16x32_bf16 v[120:123], v[60:63], a[120:123], v[120:123]
    ds_read_b64_tr_b16 v[46:47], v14 offset:9728
    s_waitcnt vmcnt(13)
    ds_read_b64_tr_b16 v[192:193], v17 offset:12288
    v_mfma_f32_16x16x32_bf16 v[124:127], v[60:63], a[124:127], v[124:127]
    ds_read_b64_tr_b16 v[194:195], v17 offset:14336
    s_waitcnt lgkmcnt(6)
    v_mfma_f32_16x16x32_bf16 v[128:131], v[32:35], a[64:67], v[128:131]
    ds_read_b64_tr_b16 v[48:49], v13 offset:12288
    ds_read_b64_tr_b16 v[196:197], v18 offset:12288
    v_mfma_f32_16x16x32_bf16 v[132:135], v[32:35], a[68:71], v[132:135]
    buffer_load_dwordx4 v2, s[8:11], s46 offen offset:1024 lds
    v_mfma_f32_16x16x32_bf16 v[136:139], v[32:35], a[72:75], v[136:139]
    ds_read_b64_tr_b16 v[50:51], v13 offset:12800
    ds_read_b64_tr_b16 v[198:199], v18 offset:14336
    v_mfma_f32_16x16x32_bf16 v[140:143], v[32:35], a[76:79], v[140:143]
    ds_read_b64_tr_b16 v[200:201], v19 offset:12288
    ds_read_b64_tr_b16 v[202:203], v19 offset:14336
    v_mfma_f32_16x16x32_bf16 v[144:147], v[36:39], a[64:67], v[144:147]
    ds_read_b64_tr_b16 v[52:53], v13 offset:13312
    v_mfma_f32_16x16x32_bf16 v[148:151], v[36:39], a[68:71], v[148:151]
    buffer_load_dwordx4 v3, s[8:11], s46 offen offset:2048 lds
    v_mfma_f32_16x16x32_bf16 v[152:155], v[36:39], a[72:75], v[152:155]
    ds_read_b64_tr_b16 v[54:55], v13 offset:13824
    v_mfma_f32_16x16x32_bf16 v[156:159], v[36:39], a[76:79], v[156:159]
    s_waitcnt lgkmcnt(10)
    v_mfma_f32_16x16x32_bf16 v[160:163], v[40:43], a[64:67], v[160:163]
    ds_read_b64_tr_b16 v[56:57], v14 offset:12288
    ds_read_b64_tr_b16 v[204:205], v20 offset:12288
    v_mfma_f32_16x16x32_bf16 v[164:167], v[40:43], a[68:71], v[164:167]
    buffer_load_dwordx4 v4, s[8:11], s46 offen offset:3072 lds
    v_mfma_f32_16x16x32_bf16 v[168:171], v[40:43], a[72:75], v[168:171]
    ds_read_b64_tr_b16 v[58:59], v14 offset:12800
    s_add_u32 m0, s45, 32768
    v_mfma_f32_16x16x32_bf16 v[172:175], v[40:43], a[76:79], v[172:175]
    v_mfma_f32_16x16x32_bf16 v[176:179], v[44:47], a[64:67], v[176:179]
    ds_read_b64_tr_b16 v[60:61], v14 offset:13312
    v_mfma_f32_16x16x32_bf16 v[180:183], v[44:47], a[68:71], v[180:183]
    buffer_load_dwordx4 v5, s[12:15], s93 offen lds
    v_mfma_f32_16x16x32_bf16 v[184:187], v[44:47], a[72:75], v[184:187]
    s_waitcnt lgkmcnt(12)
    ds_read_b64_tr_b16 v[62:63], v14 offset:13824
    v_mfma_f32_16x16x32_bf16 v[188:191], v[44:47], a[76:79], v[188:191]
    s_waitcnt vmcnt(13)
    s_barrier
    s_waitcnt lgkmcnt(5)
    v_mfma_f32_16x16x32_bf16 v[128:131], v[48:51], a[80:83], v[128:131]
    ds_read_b64_tr_b16 v[32:33], v13 offset:16384
    ds_read_b128 a[0:3], v15 offset:4096
    v_mfma_f32_16x16x32_bf16 v[132:135], v[48:51], a[84:87], v[132:135]
    ds_read_b128 a[4:7], v15 offset:6144
    ds_read_b128 a[8:11], v15 offset:24576
    v_mfma_f32_16x16x32_bf16 v[136:139], v[48:51], a[88:91], v[136:139]
    ds_read_b64_tr_b16 v[34:35], v13 offset:16896
    ds_read_b128 a[12:15], v15 offset:26624
    v_mfma_f32_16x16x32_bf16 v[140:143], v[48:51], a[92:95], v[140:143]
    ds_read_b128 a[16:19], v16 offset:4096
    ds_read_b128 a[20:23], v16 offset:6144
    v_mfma_f32_16x16x32_bf16 v[144:147], v[52:55], a[80:83], v[144:147]
    ds_read_b64_tr_b16 v[36:37], v13 offset:17408
    s_waitcnt lgkmcnt(12)
    ds_read_b128 a[24:27], v16 offset:24576
    v_mfma_f32_16x16x32_bf16 v[148:151], v[52:55], a[84:87], v[148:151]
    ds_read_b128 a[28:31], v16 offset:26624
    buffer_load_dwordx4 v5, s[16:19], s93 offen offset:1024 lds
    v_mfma_f32_16x16x32_bf16 v[152:155], v[52:55], a[88:91], v[152:155]
    s_waitcnt lgkmcnt(12)
    ds_read_b64_tr_b16 v[38:39], v13 offset:17920
    v_mfma_f32_16x16x32_bf16 v[156:159], v[52:55], a[92:95], v[156:159]
    buffer_load_dwordx4 v7, s[12:15], s93 offen offset:2048 lds
    v_mfma_f32_16x16x32_bf16 v[160:163], v[56:59], a[80:83], v[160:163]
    ds_read_b64_tr_b16 v[40:41], v14 offset:16384
    v_mfma_f32_16x16x32_bf16 v[164:167], v[56:59], a[84:87], v[164:167]
    buffer_load_dwordx4 v7, s[16:19], s93 offen offset:3072 lds
    v_mfma_f32_16x16x32_bf16 v[168:171], v[56:59], a[88:91], v[168:171]
    s_waitcnt lgkmcnt(12)
    ds_read_b64_tr_b16 v[42:43], v14 offset:16896
    v_mfma_f32_16x16x32_bf16 v[172:175], v[56:59], a[92:95], v[172:175]
    s_bfe_u32 s46, s6, 196632
    s_lshl_b32 s46, s46, 7
    v_mfma_f32_16x16x32_bf16 v[176:179], v[60:63], a[80:83], v[176:179]
    ds_read_b64_tr_b16 v[44:45], v14 offset:17408
    s_add_u32 m0, s7, 0
    v_mfma_f32_16x16x32_bf16 v[180:183], v[60:63], a[84:87], v[180:183]
    s_add_u32 s46, s46, s41
    v_mfma_f32_16x16x32_bf16 v[184:187], v[60:63], a[88:91], v[184:187]
    s_waitcnt lgkmcnt(12)
    ds_read_b64_tr_b16 v[46:47], v14 offset:17920
    v_mfma_f32_16x16x32_bf16 v[188:191], v[60:63], a[92:95], v[188:191]
    s_waitcnt lgkmcnt(4)
    v_mfma_f32_16x16x32_bf16 v[64:67], v[32:35], a[0:3], v[64:67]
    ds_read_b64_tr_b16 v[48:49], v13 offset:20480
    buffer_load_dwordx4 v1, s[8:11], s46 offen lds
    v_mfma_f32_16x16x32_bf16 v[68:71], v[32:35], a[4:7], v[68:71]
    buffer_load_dwordx4 v2, s[8:11], s46 offen offset:1024 lds
    v_mfma_f32_16x16x32_bf16 v[72:75], v[32:35], a[8:11], v[72:75]
    ds_read_b64_tr_b16 v[50:51], v13 offset:20992
    ds_read_b64_tr_b16 v[206:207], v20 offset:14336
    v_mfma_f32_16x16x32_bf16 v[76:79], v[32:35], a[12:15], v[76:79]
    s_waitcnt vmcnt(14)
    ds_read_b64_tr_b16 v[208:209], v17 offset:16384
    v_mfma_f32_16x16x32_bf16 v[80:83], v[36:39], a[0:3], v[80:83]
    ds_read_b64_tr_b16 v[52:53], v13 offset:21504
    ds_read_b64_tr_b16 v[210:211], v17 offset:18432
    v_mfma_f32_16x16x32_bf16 v[84:87], v[36:39], a[4:7], v[84:87]
    buffer_load_dwordx4 v3, s[8:11], s46 offen offset:2048 lds
    v_mfma_f32_16x16x32_bf16 v[88:91], v[36:39], a[8:11], v[88:91]
    ds_read_b64_tr_b16 v[54:55], v13 offset:22016
    ds_read_b64_tr_b16 v[212:213], v18 offset:16384
    v_mfma_f32_16x16x32_bf16 v[92:95], v[36:39], a[12:15], v[92:95]
    ds_read_b64_tr_b16 v[214:215], v18 offset:18432
    s_waitcnt lgkmcnt(9)
    v_mfma_f32_16x16x32_bf16 v[96:99], v[40:43], a[0:3], v[96:99]
    ds_read_b64_tr_b16 v[56:57], v14 offset:20480
    ds_read_b64_tr_b16 v[216:217], v19 offset:16384
    v_mfma_f32_16x16x32_bf16 v[100:103], v[40:43], a[4:7], v[100:103]
    buffer_load_dwordx4 v4, s[8:11], s46 offen offset:3072 lds
    v_mfma_f32_16x16x32_bf16 v[104:107], v[40:43], a[8:11], v[104:107]
    ds_read_b64_tr_b16 v[58:59], v14 offset:20992
    s_waitcnt lgkmcnt(9)
    v_mfma_f32_16x16x32_bf16 v[108:111], v[40:43], a[12:15], v[108:111]
    s_add_u32 m0, s45, 0
    ds_read_b64_tr_b16 v[218:219], v19 offset:18432
    v_mfma_f32_16x16x32_bf16 v[112:115], v[44:47], a[0:3], v[112:115]
    ds_read_b64_tr_b16 v[60:61], v14 offset:21504
    ds_read_b64_tr_b16 v[220:221], v20 offset:16384
    v_mfma_f32_16x16x32_bf16 v[116:119], v[44:47], a[4:7], v[116:119]
    buffer_load_dwordx4 v5, s[12:15], s94 offen lds
    v_mfma_f32_16x16x32_bf16 v[120:123], v[44:47], a[8:11], v[120:123]
    ds_read_b64_tr_b16 v[62:63], v14 offset:22016
    v_mfma_f32_16x16x32_bf16 v[124:127], v[44:47], a[12:15], v[124:127]
    s_waitcnt vmcnt(13)
    s_barrier
    s_waitcnt lgkmcnt(9)
    v_mfma_f32_16x16x32_bf16 v[64:67], v[48:51], a[16:19], v[64:67]
    ds_read_b64_tr_b16 v[32:33], v13 offset:24576
    ds_read_b64_tr_b16 v[222:223], v20 offset:18432
    v_mfma_f32_16x16x32_bf16 v[68:71], v[48:51], a[20:23], v[68:71]
    buffer_load_dwordx4 v5, s[16:19], s94 offen offset:1024 lds
    v_mfma_f32_16x16x32_bf16 v[72:75], v[48:51], a[24:27], v[72:75]
    ds_read_b64_tr_b16 v[34:35], v13 offset:25088
    v_mfma_f32_16x16x32_bf16 v[76:79], v[48:51], a[28:31], v[76:79]
    v_mfma_f32_16x16x32_bf16 v[80:83], v[52:55], a[16:19], v[80:83]
    ds_read_b64_tr_b16 v[36:37], v13 offset:25600
    v_mfma_f32_16x16x32_bf16 v[84:87], v[52:55], a[20:23], v[84:87]
    buffer_load_dwordx4 v7, s[12:15], s94 offen offset:2048 lds
    v_mfma_f32_16x16x32_bf16 v[88:91], v[52:55], a[24:27], v[88:91]
    ds_read_b64_tr_b16 v[38:39], v13 offset:26112
    v_mfma_f32_16x16x32_bf16 v[92:95], v[52:55], a[28:31], v[92:95]
    s_waitcnt lgkmcnt(5)
    v_mfma_f32_16x16x32_bf16 v[96:99], v[56:59], a[16:19], v[96:99]
    ds_read_b64_tr_b16 v[40:41], v14 offset:24576
    s_waitcnt lgkmcnt(4)
    v_mfma_f32_16x16x32_bf16 v[100:103], v[56:59], a[20:23], v[100:103]
    buffer_load_dwordx4 v7, s[16:19], s94 offen offset:3072 lds
    v_mfma_f32_16x16x32_bf16 v[104:107], v[56:59], a[24:27], v[104:107]
    ds_read_b64_tr_b16 v[42:43], v14 offset:25088
    s_bfe_u32 s46, s6, 196636
    v_mfma_f32_16x16x32_bf16 v[108:111], v[56:59], a[28:31], v[108:111]
    s_lshl_b32 s46, s46, 7
    s_add_u32 m0, s7, 4096
    v_mfma_f32_16x16x32_bf16 v[112:115], v[60:63], a[16:19], v[112:115]
    ds_read_b64_tr_b16 v[44:45], v14 offset:25600
    s_add_u32 s46, s46, s41
    v_mfma_f32_16x16x32_bf16 v[116:119], v[60:63], a[20:23], v[116:119]
    buffer_load_dwordx4 v1, s[8:11], s46 offen lds
    v_mfma_f32_16x16x32_bf16 v[120:123], v[60:63], a[24:27], v[120:123]
    ds_read_b64_tr_b16 v[46:47], v14 offset:26112
    v_mfma_f32_16x16x32_bf16 v[124:127], v[60:63], a[28:31], v[124:127]
    s_waitcnt lgkmcnt(4)
    v_mfma_f32_16x16x32_bf16 v[128:131], v[32:35], a[96:99], v[128:131]
    ds_read_b64_tr_b16 v[48:49], v13 offset:28672
    v_mfma_f32_16x16x32_bf16 v[132:135], v[32:35], a[100:103], v[132:135]
    buffer_load_dwordx4 v2, s[8:11], s46 offen offset:1024 lds
    v_mfma_f32_16x16x32_bf16 v[136:139], v[32:35], a[104:107], v[136:139]
    ds_read_b64_tr_b16 v[50:51], v13 offset:29184
    v_mfma_f32_16x16x32_bf16 v[140:143], v[32:35], a[108:111], v[140:143]
    v_mfma_f32_16x16x32_bf16 v[144:147], v[36:39], a[96:99], v[144:147]
    ds_read_b64_tr_b16 v[52:53], v13 offset:29696
    v_mfma_f32_16x16x32_bf16 v[148:151], v[36:39], a[100:103], v[148:151]
    buffer_load_dwordx4 v3, s[8:11], s46 offen offset:2048 lds
    v_mfma_f32_16x16x32_bf16 v[152:155], v[36:39], a[104:107], v[152:155]
    ds_read_b64_tr_b16 v[54:55], v13 offset:30208
    v_mfma_f32_16x16x32_bf16 v[156:159], v[36:39], a[108:111], v[156:159]
    s_waitcnt lgkmcnt(4)
    v_mfma_f32_16x16x32_bf16 v[160:163], v[40:43], a[96:99], v[160:163]
    ds_read_b64_tr_b16 v[56:57], v14 offset:28672
    v_mfma_f32_16x16x32_bf16 v[164:167], v[40:43], a[100:103], v[164:167]
    buffer_load_dwordx4 v4, s[8:11], s46 offen offset:3072 lds
    s_sub_u32 s58, s45, s44
    v_add_u32 v1, s58, v17
    v_add_u32 v2, s58, v18
    v_add_u32 v3, s58, v19
    v_add_u32 v4, s58, v20
    v_mfma_f32_16x16x32_bf16 v[168:171], v[40:43], a[104:107], v[168:171]
    ds_read_b64_tr_b16 v[58:59], v14 offset:29184
    s_add_u32 m0, s45, 8192
    v_mfma_f32_16x16x32_bf16 v[172:175], v[40:43], a[108:111], v[172:175]
    v_mfma_f32_16x16x32_bf16 v[176:179], v[44:47], a[96:99], v[176:179]
    ds_read_b64_tr_b16 v[60:61], v14 offset:29696
    v_mfma_f32_16x16x32_bf16 v[180:183], v[44:47], a[100:103], v[180:183]
    buffer_load_dwordx4 v5, s[12:15], s49 offen lds
    v_mfma_f32_16x16x32_bf16 v[184:187], v[44:47], a[104:107], v[184:187]
    ds_read_b64_tr_b16 v[62:63], v14 offset:30208
    v_mfma_f32_16x16x32_bf16 v[188:191], v[44:47], a[108:111], v[188:191]
    s_waitcnt vmcnt(13)
    s_barrier
    s_waitcnt lgkmcnt(4)
    v_mfma_f32_16x16x32_bf16 v[128:131], v[48:51], a[112:115], v[128:131]
    ds_read_b64_tr_b16 v[32:33], v13 offset:32768
    ds_read_b128 a[32:35], v15 offset:8192
    v_mfma_f32_16x16x32_bf16 v[132:135], v[48:51], a[116:119], v[132:135]
    ds_read_b128 a[36:39], v15 offset:10240
    ds_read_b128 a[40:43], v15 offset:28672
    v_mfma_f32_16x16x32_bf16 v[136:139], v[48:51], a[120:123], v[136:139]
    ds_read_b64_tr_b16 v[34:35], v13 offset:33280
    ds_read_b128 a[44:47], v15 offset:30720
    v_mfma_f32_16x16x32_bf16 v[140:143], v[48:51], a[124:127], v[140:143]
    ds_read_b128 a[48:51], v16 offset:8192
    ds_read_b128 a[52:55], v16 offset:10240
    v_mfma_f32_16x16x32_bf16 v[144:147], v[52:55], a[112:115], v[144:147]
    ds_read_b64_tr_b16 v[36:37], v13 offset:33792
    ds_read_b128 a[56:59], v16 offset:28672
    buffer_load_dwordx4 v5, s[16:19], s49 offen offset:1024 lds
    v_mfma_f32_16x16x32_bf16 v[148:151], v[52:55], a[116:119], v[148:151]
    s_waitcnt lgkmcnt(12)
    ds_read_b128 a[60:63], v16 offset:30720
    v_mfma_f32_16x16x32_bf16 v[152:155], v[52:55], a[120:123], v[152:155]
    ds_read_b64_tr_b16 v[38:39], v13 offset:34304
    v_mfma_f32_16x16x32_bf16 v[156:159], v[52:55], a[124:127], v[156:159]
    buffer_load_dwordx4 v7, s[12:15], s49 offen offset:2048 lds
    s_waitcnt lgkmcnt(12)
    v_mfma_f32_16x16x32_bf16 v[160:163], v[56:59], a[112:115], v[160:163]
    ds_read_b64_tr_b16 v[40:41], v14 offset:32768
    v_mfma_f32_16x16x32_bf16 v[164:167], v[56:59], a[116:119], v[164:167]
    buffer_load_dwordx4 v7, s[16:19], s49 offen offset:3072 lds
    v_mfma_f32_16x16x32_bf16 v[168:171], v[56:59], a[120:123], v[168:171]
    ds_read_b64_tr_b16 v[42:43], v14 offset:33280
    s_add_u32 m0, s44, 16384
    v_mfma_f32_16x16x32_bf16 v[172:175], v[56:59], a[124:127], v[172:175]
    v_mfma_f32_16x16x32_bf16 v[176:179], v[60:63], a[112:115], v[176:179]
    s_waitcnt lgkmcnt(12)
    ds_read_b64_tr_b16 v[44:45], v14 offset:33792
    v_mfma_f32_16x16x32_bf16 v[180:183], v[60:63], a[116:119], v[180:183]
    buffer_load_dwordx4 v9, s[20:23], s97 offen lds
    v_mfma_f32_16x16x32_bf16 v[184:187], v[60:63], a[120:123], v[184:187]
    ds_read_b64_tr_b16 v[46:47], v14 offset:34304
    v_mfma_f32_16x16x32_bf16 v[188:191], v[60:63], a[124:127], v[188:191]
    s_waitcnt lgkmcnt(4)
    v_mfma_f32_16x16x32_bf16 v[64:67], v[32:35], a[32:35], v[64:67]
    ds_read_b64_tr_b16 v[48:49], v13 offset:36864
    v_mfma_f32_16x16x32_bf16 v[68:71], v[32:35], a[36:39], v[68:71]
    buffer_load_dwordx4 v10, s[20:23], s97 offen offset:1024 lds
    v_mfma_f32_16x16x32_bf16 v[72:75], v[32:35], a[40:43], v[72:75]
    ds_read_b64_tr_b16 v[50:51], v13 offset:37376
    v_mfma_f32_16x16x32_bf16 v[76:79], v[32:35], a[44:47], v[76:79]
    v_mfma_f32_16x16x32_bf16 v[80:83], v[36:39], a[32:35], v[80:83]
    ds_read_b64_tr_b16 v[52:53], v13 offset:37888
    v_mfma_f32_16x16x32_bf16 v[84:87], v[36:39], a[36:39], v[84:87]
    buffer_load_dwordx4 v11, s[20:23], s97 offen offset:2048 lds
    v_mfma_f32_16x16x32_bf16 v[88:91], v[36:39], a[40:43], v[88:91]
    ds_read_b64_tr_b16 v[54:55], v13 offset:38400
    v_mfma_f32_16x16x32_bf16 v[92:95], v[36:39], a[44:47], v[92:95]
    s_waitcnt lgkmcnt(4)
    v_mfma_f32_16x16x32_bf16 v[96:99], v[40:43], a[32:35], v[96:99]
    ds_read_b64_tr_b16 v[56:57], v14 offset:36864
    v_mfma_f32_16x16x32_bf16 v[100:103], v[40:43], a[36:39], v[100:103]
    buffer_load_dwordx4 v12, s[20:23], s97 offen offset:3072 lds
    v_mfma_f32_16x16x32_bf16 v[104:107], v[40:43], a[40:43], v[104:107]
    ds_read_b64_tr_b16 v[58:59], v14 offset:37376
    s_add_u32 m0, s45, 16384
    v_mfma_f32_16x16x32_bf16 v[108:111], v[40:43], a[44:47], v[108:111]
    v_mfma_f32_16x16x32_bf16 v[112:115], v[44:47], a[32:35], v[112:115]
    ds_read_b64_tr_b16 v[60:61], v14 offset:37888
    v_mfma_f32_16x16x32_bf16 v[116:119], v[44:47], a[36:39], v[116:119]
    buffer_load_dwordx4 v6, s[12:15], s92 offen lds
    v_mfma_f32_16x16x32_bf16 v[120:123], v[44:47], a[40:43], v[120:123]
    ds_read_b64_tr_b16 v[62:63], v14 offset:38400
    v_mfma_f32_16x16x32_bf16 v[124:127], v[44:47], a[44:47], v[124:127]
    s_waitcnt vmcnt(13)
    s_barrier
    s_waitcnt lgkmcnt(4)
    v_mfma_f32_16x16x32_bf16 v[64:67], v[48:51], a[48:51], v[64:67]
    ds_read_b64_tr_b16 v[32:33], v13 offset:0
    ds_read_b128 a[64:67], v15 offset:0
    v_mfma_f32_16x16x32_bf16 v[68:71], v[48:51], a[52:55], v[68:71]
    ds_read_b128 a[68:71], v15 offset:2048
    ds_read_b128 a[72:75], v15 offset:20480
    v_mfma_f32_16x16x32_bf16 v[72:75], v[48:51], a[56:59], v[72:75]
    ds_read_b64_tr_b16 v[34:35], v13 offset:512
    ds_read_b128 a[76:79], v15 offset:22528
    v_mfma_f32_16x16x32_bf16 v[76:79], v[48:51], a[60:63], v[76:79]
    ds_read_b128 a[80:83], v16 offset:0
    ds_read_b128 a[84:87], v16 offset:2048
    v_mfma_f32_16x16x32_bf16 v[80:83], v[52:55], a[48:51], v[80:83]
    ds_read_b64_tr_b16 v[36:37], v13 offset:1024
    ds_read_b128 a[88:91], v16 offset:20480
    buffer_load_dwordx4 v6, s[16:19], s92 offen offset:1024 lds
    v_mfma_f32_16x16x32_bf16 v[84:87], v[52:55], a[52:55], v[84:87]
    s_waitcnt lgkmcnt(12)
    ds_read_b128 a[92:95], v16 offset:22528
    v_mfma_f32_16x16x32_bf16 v[88:91], v[52:55], a[56:59], v[88:91]
    ds_read_b64_tr_b16 v[38:39], v13 offset:1536
    v_mfma_f32_16x16x32_bf16 v[92:95], v[52:55], a[60:63], v[92:95]
    buffer_load_dwordx4 v8, s[12:15], s92 offen offset:2048 lds
    s_waitcnt lgkmcnt(12)
    v_mfma_f32_16x16x32_bf16 v[96:99], v[56:59], a[48:51], v[96:99]
    ds_read_b64_tr_b16 v[40:41], v14 offset:0
    v_mfma_f32_16x16x32_bf16 v[100:103], v[56:59], a[52:55], v[100:103]
    buffer_load_dwordx4 v8, s[16:19], s92 offen offset:3072 lds
    v_mfma_f32_16x16x32_bf16 v[104:107], v[56:59], a[56:59], v[104:107]
    ds_read_b64_tr_b16 v[42:43], v14 offset:512
    s_add_u32 m0, s45, 24576
    v_mfma_f32_16x16x32_bf16 v[108:111], v[56:59], a[60:63], v[108:111]
    v_mfma_f32_16x16x32_bf16 v[112:115], v[60:63], a[48:51], v[112:115]
    s_waitcnt lgkmcnt(12)
    ds_read_b64_tr_b16 v[44:45], v14 offset:1024
    v_mfma_f32_16x16x32_bf16 v[116:119], v[60:63], a[52:55], v[116:119]
    buffer_load_dwordx4 v6, s[12:15], s93 offen lds
    v_mfma_f32_16x16x32_bf16 v[120:123], v[60:63], a[56:59], v[120:123]
    ds_read_b64_tr_b16 v[46:47], v14 offset:1536
    v_mfma_f32_16x16x32_bf16 v[124:127], v[60:63], a[60:63], v[124:127]
    s_waitcnt lgkmcnt(4)
    v_mfma_f32_16x16x32_bf16 v[64:67], v[32:35], a[64:67], v[64:67]
    ds_read_b64_tr_b16 v[48:49], v13 offset:4096
    v_mfma_f32_16x16x32_bf16 v[68:71], v[32:35], a[68:71], v[68:71]
    buffer_load_dwordx4 v6, s[16:19], s93 offen offset:1024 lds
    v_mfma_f32_16x16x32_bf16 v[72:75], v[32:35], a[72:75], v[72:75]
    ds_read_b64_tr_b16 v[50:51], v13 offset:4608
    v_mfma_f32_16x16x32_bf16 v[76:79], v[32:35], a[76:79], v[76:79]
    v_mfma_f32_16x16x32_bf16 v[80:83], v[36:39], a[64:67], v[80:83]
    ds_read_b64_tr_b16 v[52:53], v13 offset:5120
    v_mfma_f32_16x16x32_bf16 v[84:87], v[36:39], a[68:71], v[84:87]
    buffer_load_dwordx4 v8, s[12:15], s93 offen offset:2048 lds
    v_mfma_f32_16x16x32_bf16 v[88:91], v[36:39], a[72:75], v[88:91]
    ds_read_b64_tr_b16 v[54:55], v13 offset:5632
    v_mfma_f32_16x16x32_bf16 v[92:95], v[36:39], a[76:79], v[92:95]
    s_waitcnt lgkmcnt(4)
    v_mfma_f32_16x16x32_bf16 v[96:99], v[40:43], a[64:67], v[96:99]
    ds_read_b64_tr_b16 v[56:57], v14 offset:4096
    v_mfma_f32_16x16x32_bf16 v[100:103], v[40:43], a[68:71], v[100:103]
    buffer_load_dwordx4 v8, s[16:19], s93 offen offset:3072 lds
    v_mfma_f32_16x16x32_bf16 v[104:107], v[40:43], a[72:75], v[104:107]
    ds_read_b64_tr_b16 v[58:59], v14 offset:4608
    s_add_u32 m0, s44, 12288
    v_mfma_f32_16x16x32_bf16 v[108:111], v[40:43], a[76:79], v[108:111]
    s_xor_b32 s46, s95, 65536
    v_mfma_f32_16x16x32_bf16 v[112:115], v[44:47], a[64:67], v[112:115]
    ds_read_b64_tr_b16 v[60:61], v14 offset:5120
    v_mfma_f32_16x16x32_bf16 v[116:119], v[44:47], a[68:71], v[116:119]
    buffer_load_dwordx4 v9, s[20:23], s46 offen lds
    v_mfma_f32_16x16x32_bf16 v[120:123], v[44:47], a[72:75], v[120:123]
    ds_read_b64_tr_b16 v[62:63], v14 offset:5632
    v_mfma_f32_16x16x32_bf16 v[124:127], v[44:47], a[76:79], v[124:127]
    s_waitcnt vmcnt(13)
    s_barrier
    s_waitcnt lgkmcnt(4)
    v_mfma_f32_16x16x32_bf16 v[64:67], v[48:51], a[80:83], v[64:67]
    ds_read_b64_tr_b16 v[32:33], v13 offset:8192
    ds_read_b128 a[96:99], v15 offset:4096
    v_mfma_f32_16x16x32_bf16 v[68:71], v[48:51], a[84:87], v[68:71]
    ds_read_b128 a[100:103], v15 offset:6144
    ds_read_b128 a[104:107], v15 offset:24576
    v_mfma_f32_16x16x32_bf16 v[72:75], v[48:51], a[88:91], v[72:75]
    ds_read_b64_tr_b16 v[34:35], v13 offset:8704
    ds_read_b128 a[108:111], v15 offset:26624
    v_mfma_f32_16x16x32_bf16 v[76:79], v[48:51], a[92:95], v[76:79]
    ds_read_b128 a[112:115], v16 offset:4096
    ds_read_b128 a[116:119], v16 offset:6144
    v_mfma_f32_16x16x32_bf16 v[80:83], v[52:55], a[80:83], v[80:83]
    ds_read_b64_tr_b16 v[36:37], v13 offset:9216
    ds_read_b128 a[120:123], v16 offset:24576
    buffer_load_dwordx4 v10, s[20:23], s46 offen offset:1024 lds
    v_mfma_f32_16x16x32_bf16 v[84:87], v[52:55], a[84:87], v[84:87]
    s_waitcnt lgkmcnt(12)
    ds_read_b128 a[124:127], v16 offset:26624
    v_mfma_f32_16x16x32_bf16 v[88:91], v[52:55], a[88:91], v[88:91]
    ds_read_b64_tr_b16 v[38:39], v13 offset:9728
    v_mfma_f32_16x16x32_bf16 v[92:95], v[52:55], a[92:95], v[92:95]
    buffer_load_dwordx4 v11, s[20:23], s46 offen offset:2048 lds
    s_waitcnt lgkmcnt(12)
    v_mfma_f32_16x16x32_bf16 v[96:99], v[56:59], a[80:83], v[96:99]
    ds_read_b64_tr_b16 v[40:41], v14 offset:8192
    v_mfma_f32_16x16x32_bf16 v[100:103], v[56:59], a[84:87], v[100:103]
    buffer_load_dwordx4 v12, s[20:23], s46 offen offset:3072 lds
    v_mfma_f32_16x16x32_bf16 v[104:107], v[56:59], a[88:91], v[104:107]
    ds_read_b64_tr_b16 v[42:43], v14 offset:8704
    s_add_u32 m0, s45, 32768
    v_mfma_f32_16x16x32_bf16 v[108:111], v[56:59], a[92:95], v[108:111]
    v_mfma_f32_16x16x32_bf16 v[112:115], v[60:63], a[80:83], v[112:115]
    s_waitcnt lgkmcnt(12)
    ds_read_b64_tr_b16 v[44:45], v14 offset:9216
    v_mfma_f32_16x16x32_bf16 v[116:119], v[60:63], a[84:87], v[116:119]
    buffer_load_dwordx4 v6, s[12:15], s94 offen lds
    v_mfma_f32_16x16x32_bf16 v[120:123], v[60:63], a[88:91], v[120:123]
    ds_read_b64_tr_b16 v[46:47], v14 offset:9728
    v_mfma_f32_16x16x32_bf16 v[124:127], v[60:63], a[92:95], v[124:127]
    s_waitcnt lgkmcnt(4)
    v_mfma_f32_16x16x32_bf16 v[64:67], v[32:35], a[96:99], v[64:67]
    ds_read_b64_tr_b16 v[48:49], v13 offset:12288
    s_waitcnt vmcnt(13)
    ds_read_b64_tr_b16 v[224:225], v17 offset:16384
    v_mfma_f32_16x16x32_bf16 v[68:71], v[32:35], a[100:103], v[68:71]
    buffer_load_dwordx4 v6, s[16:19], s94 offen offset:1024 lds
    v_mfma_f32_16x16x32_bf16 v[72:75], v[32:35], a[104:107], v[72:75]
    ds_read_b64_tr_b16 v[50:51], v13 offset:12800
    ds_read_b64_tr_b16 v[226:227], v17 offset:18432
    v_mfma_f32_16x16x32_bf16 v[76:79], v[32:35], a[108:111], v[76:79]
    ds_read_b64_tr_b16 v[228:229], v18 offset:16384
    ds_read_b64_tr_b16 v[230:231], v18 offset:18432
    v_mfma_f32_16x16x32_bf16 v[80:83], v[36:39], a[96:99], v[80:83]
    ds_read_b64_tr_b16 v[52:53], v13 offset:13312
    ds_read_b64_tr_b16 v[232:233], v19 offset:16384
    v_mfma_f32_16x16x32_bf16 v[84:87], v[36:39], a[100:103], v[84:87]
    buffer_load_dwordx4 v8, s[12:15], s94 offen offset:2048 lds
    v_mfma_f32_16x16x32_bf16 v[88:91], v[36:39], a[104:107], v[88:91]
    ds_read_b64_tr_b16 v[54:55], v13 offset:13824
    v_mfma_f32_16x16x32_bf16 v[92:95], v[36:39], a[108:111], v[92:95]
    s_waitcnt lgkmcnt(9)
    v_mfma_f32_16x16x32_bf16 v[96:99], v[40:43], a[96:99], v[96:99]
    ds_read_b64_tr_b16 v[56:57], v14 offset:12288
    ds_read_b64_tr_b16 v[234:235], v19 offset:18432
    v_mfma_f32_16x16x32_bf16 v[100:103], v[40:43], a[100:103], v[100:103]
    buffer_load_dwordx4 v8, s[16:19], s94 offen offset:3072 lds
    v_mfma_f32_16x16x32_bf16 v[104:107], v[40:43], a[104:107], v[104:107]
    ds_read_b64_tr_b16 v[58:59], v14 offset:12800
    s_add_u32 m0, s44, 8192
    v_mfma_f32_16x16x32_bf16 v[108:111], v[40:43], a[108:111], v[108:111]
    s_xor_b32 s46, s96, 65536
    ds_read_b64_tr_b16 v[236:237], v20 offset:16384
    v_mfma_f32_16x16x32_bf16 v[112:115], v[44:47], a[96:99], v[112:115]
    ds_read_b64_tr_b16 v[60:61], v14 offset:13312
    v_mfma_f32_16x16x32_bf16 v[116:119], v[44:47], a[100:103], v[116:119]
    buffer_load_dwordx4 v9, s[20:23], s46 offen lds
    v_mfma_f32_16x16x32_bf16 v[120:123], v[44:47], a[104:107], v[120:123]
    s_waitcnt lgkmcnt(12)
    ds_read_b64_tr_b16 v[62:63], v14 offset:13824
    v_mfma_f32_16x16x32_bf16 v[124:127], v[44:47], a[108:111], v[124:127]
    s_waitcnt vmcnt(13)
    s_barrier
    s_waitcnt lgkmcnt(6)
    v_mfma_f32_16x16x32_bf16 v[64:67], v[48:51], a[112:115], v[64:67]
    ds_read_b64_tr_b16 v[32:33], v13 offset:16384
    ds_read_b64_tr_b16 v[238:239], v20 offset:18432
    v_mfma_f32_16x16x32_bf16 v[68:71], v[48:51], a[116:119], v[68:71]
    buffer_load_dwordx4 v10, s[20:23], s46 offen offset:1024 lds
    v_mfma_f32_16x16x32_bf16 v[72:75], v[48:51], a[120:123], v[72:75]
    ds_read_b64_tr_b16 v[34:35], v13 offset:16896
    v_mfma_f32_16x16x32_bf16 v[76:79], v[48:51], a[124:127], v[76:79]
    v_mfma_f32_16x16x32_bf16 v[80:83], v[52:55], a[112:115], v[80:83]
    ds_read_b64_tr_b16 v[36:37], v13 offset:17408
    v_mfma_f32_16x16x32_bf16 v[84:87], v[52:55], a[116:119], v[84:87]
    buffer_load_dwordx4 v11, s[20:23], s46 offen offset:2048 lds
    v_mfma_f32_16x16x32_bf16 v[88:91], v[52:55], a[120:123], v[88:91]
    ds_read_b64_tr_b16 v[38:39], v13 offset:17920
    v_mfma_f32_16x16x32_bf16 v[92:95], v[52:55], a[124:127], v[92:95]
    s_waitcnt lgkmcnt(5)
    v_mfma_f32_16x16x32_bf16 v[96:99], v[56:59], a[112:115], v[96:99]
    ds_read_b64_tr_b16 v[40:41], v14 offset:16384
    s_waitcnt lgkmcnt(4)
    v_mfma_f32_16x16x32_bf16 v[100:103], v[56:59], a[116:119], v[100:103]
    buffer_load_dwordx4 v12, s[20:23], s46 offen offset:3072 lds
    v_mfma_f32_16x16x32_bf16 v[104:107], v[56:59], a[120:123], v[104:107]
    ds_read_b64_tr_b16 v[42:43], v14 offset:16896
    s_add_u32 m0, s45, 0
    v_mfma_f32_16x16x32_bf16 v[108:111], v[56:59], a[124:127], v[108:111]
    v_mfma_f32_16x16x32_bf16 v[112:115], v[60:63], a[112:115], v[112:115]
    ds_read_b64_tr_b16 v[44:45], v14 offset:17408
    v_mfma_f32_16x16x32_bf16 v[116:119], v[60:63], a[116:119], v[116:119]
    buffer_load_dwordx4 v6, s[12:15], s49 offen lds
    v_mfma_f32_16x16x32_bf16 v[120:123], v[60:63], a[120:123], v[120:123]
    ds_read_b64_tr_b16 v[46:47], v14 offset:17920
    v_mfma_f32_16x16x32_bf16 v[124:127], v[60:63], a[124:127], v[124:127]
    s_waitcnt lgkmcnt(4)
    v_mfma_f32_16x16x32_bf16 v[128:131], v[32:35], a[0:3], v[128:131]
    ds_read_b64_tr_b16 v[48:49], v13 offset:20480
    s_mov_b64 exec, 3
    buffer_load_dword v30, v27, s[32:35], 0 offen sc1
    s_mov_b64 exec, -1
    v_mfma_f32_16x16x32_bf16 v[132:135], v[32:35], a[4:7], v[132:135]
    v_mfma_f32_16x16x32_bf16 v[136:139], v[32:35], a[8:11], v[136:139]
    ds_read_b64_tr_b16 v[50:51], v13 offset:20992
    v_mfma_f32_16x16x32_bf16 v[140:143], v[32:35], a[12:15], v[140:143]
    buffer_load_dwordx4 v6, s[16:19], s49 offen offset:1024 lds
    v_mfma_f32_16x16x32_bf16 v[144:147], v[36:39], a[0:3], v[144:147]
    ds_read_b64_tr_b16 v[52:53], v13 offset:21504
    v_mfma_f32_16x16x32_bf16 v[148:151], v[36:39], a[4:7], v[148:151]
    v_pk_mul_f32 v[64:65], v[64:65], v[80:81]
    v_pk_mul_f32 v[66:67], v[66:67], v[82:83]
    v_pk_mul_f32 v[96:97], v[96:97], v[112:113]
    v_mfma_f32_16x16x32_bf16 v[152:155], v[36:39], a[8:11], v[152:155]
    ds_read_b64_tr_b16 v[54:55], v13 offset:22016
    v_pk_mul_f32 v[98:99], v[98:99], v[114:115]
    v_cvt_pk_bf16_f32 v240, v64, v65
    v_mfma_f32_16x16x32_bf16 v[156:159], v[36:39], a[12:15], v[156:159]
    v_cvt_pk_bf16_f32 v241, v66, v67
    v_cvt_pk_bf16_f32 v242, v96, v97
    s_waitcnt lgkmcnt(4)
    v_mfma_f32_16x16x32_bf16 v[160:163], v[40:43], a[0:3], v[160:163]
    ds_read_b64_tr_b16 v[56:57], v14 offset:20480
    v_cvt_pk_bf16_f32 v243, v98, v99
    buffer_store_dwordx4 v[240:243], v25, s[24:27], s50 offen sc1
    v_mfma_f32_16x16x32_bf16 v[164:167], v[40:43], a[4:7], v[164:167]
    buffer_load_dwordx4 v8, s[12:15], s49 offen offset:2048 lds
    v_pk_mul_f32 v[68:69], v[68:69], v[84:85]
    v_mfma_f32_16x16x32_bf16 v[168:171], v[40:43], a[8:11], v[168:171]
    ds_read_b64_tr_b16 v[58:59], v14 offset:20992
    v_pk_mul_f32 v[70:71], v[70:71], v[86:87]
    v_pk_mul_f32 v[100:101], v[100:101], v[116:117]
    v_mfma_f32_16x16x32_bf16 v[172:175], v[40:43], a[12:15], v[172:175]
    buffer_load_dwordx4 v8, s[16:19], s49 offen offset:3072 lds
    v_pk_mul_f32 v[102:103], v[102:103], v[118:119]
    v_mfma_f32_16x16x32_bf16 v[176:179], v[44:47], a[0:3], v[176:179]
    ds_read_b64_tr_b16 v[60:61], v14 offset:21504
    v_cvt_pk_bf16_f32 v244, v68, v69
    v_cvt_pk_bf16_f32 v245, v70, v71
    v_mfma_f32_16x16x32_bf16 v[180:183], v[44:47], a[4:7], v[180:183]
    s_add_u32 m0, s44, 16384
    s_xor_b32 s46, s97, 65536
    v_cvt_pk_bf16_f32 v246, v100, v101
    v_mfma_f32_16x16x32_bf16 v[184:187], v[44:47], a[8:11], v[184:187]
    ds_read_b64_tr_b16 v[62:63], v14 offset:22016
    v_cvt_pk_bf16_f32 v247, v102, v103
    buffer_store_dwordx4 v[244:247], v25, s[24:27], s50 offen offset:1024 sc1
    v_mfma_f32_16x16x32_bf16 v[188:191], v[44:47], a[12:15], v[188:191]
    s_waitcnt vmcnt(19)
    s_barrier
    s_waitcnt lgkmcnt(4)
    v_mfma_f32_16x16x32_bf16 v[128:131], v[48:51], a[16:19], v[128:131]
    ds_read_b64_tr_b16 v[32:33], v13 offset:24576
    v_pk_mul_f32 v[72:73], v[72:73], v[88:89]
    v_pk_mul_f32 v[74:75], v[74:75], v[90:91]
    v_mfma_f32_16x16x32_bf16 v[132:135], v[48:51], a[20:23], v[132:135]
    buffer_load_dwordx4 v9, s[20:23], s46 offen lds
    v_pk_mul_f32 v[104:105], v[104:105], v[120:121]
    v_mfma_f32_16x16x32_bf16 v[136:139], v[48:51], a[24:27], v[136:139]
    ds_read_b64_tr_b16 v[34:35], v13 offset:25088
    v_pk_mul_f32 v[106:107], v[106:107], v[122:123]
    v_cvt_pk_bf16_f32 v248, v72, v73
    v_mfma_f32_16x16x32_bf16 v[140:143], v[48:51], a[28:31], v[140:143]
    s_waitcnt vmcnt(16)
    ds_read_b64_tr_b16 a[128:129], v17 offset:12288
    v_cvt_pk_bf16_f32 v249, v74, v75
    v_mfma_f32_16x16x32_bf16 v[144:147], v[52:55], a[16:19], v[144:147]
    ds_read_b64_tr_b16 v[36:37], v13 offset:25600
    v_cvt_pk_bf16_f32 v250, v104, v105
    v_cvt_pk_bf16_f32 v251, v106, v107
    v_mfma_f32_16x16x32_bf16 v[148:151], v[52:55], a[20:23], v[148:151]
    buffer_load_dwordx4 v10, s[20:23], s46 offen offset:1024 lds
    buffer_store_dwordx4 v[248:251], v25, s[24:27], s50 offen offset:2048 sc1
    v_mfma_f32_16x16x32_bf16 v[152:155], v[52:55], a[24:27], v[152:155]
    ds_read_b64_tr_b16 v[38:39], v13 offset:26112
    v_pk_mul_f32 v[76:77], v[76:77], v[92:93]
    v_pk_mul_f32 v[78:79], v[78:79], v[94:95]
    v_mfma_f32_16x16x32_bf16 v[156:159], v[52:55], a[28:31], v[156:159]
    ds_read_b64_tr_b16 a[130:131], v17 offset:14336
    v_pk_mul_f32 v[108:109], v[108:109], v[124:125]
    s_waitcnt lgkmcnt(6)
    v_mfma_f32_16x16x32_bf16 v[160:163], v[56:59], a[16:19], v[160:163]
    ds_read_b64_tr_b16 v[40:41], v14 offset:24576
    v_pk_mul_f32 v[110:111], v[110:111], v[126:127]
    v_cvt_pk_bf16_f32 v252, v76, v77
    v_mfma_f32_16x16x32_bf16 v[164:167], v[56:59], a[20:23], v[164:167]
    buffer_load_dwordx4 v11, s[20:23], s46 offen offset:2048 lds
    v_cvt_pk_bf16_f32 v253, v78, v79
    v_mfma_f32_16x16x32_bf16 v[168:171], v[56:59], a[24:27], v[168:171]
    ds_read_b64_tr_b16 v[42:43], v14 offset:25088
    v_cvt_pk_bf16_f32 v254, v108, v109
    v_cvt_pk_bf16_f32 v255, v110, v111
    v_mfma_f32_16x16x32_bf16 v[172:175], v[56:59], a[28:31], v[172:175]
    ds_read_b64_tr_b16 a[132:133], v18 offset:12288
    buffer_store_dwordx4 v[252:255], v25, s[24:27], s50 offen offset:3072 sc1
    v_mfma_f32_16x16x32_bf16 v[176:179], v[60:63], a[16:19], v[176:179]
    ds_read_b64_tr_b16 v[44:45], v14 offset:25600
    ds_read_b64_tr_b16 a[134:135], v18 offset:14336
    v_mfma_f32_16x16x32_bf16 v[180:183], v[60:63], a[20:23], v[180:183]
    buffer_load_dwordx4 v12, s[20:23], s46 offen offset:3072 lds
    v_mfma_f32_16x16x32_bf16 v[184:187], v[60:63], a[24:27], v[184:187]
    ds_read_b64_tr_b16 v[46:47], v14 offset:26112
    ds_read_b64_tr_b16 a[136:137], v19 offset:12288
    v_mfma_f32_16x16x32_bf16 v[188:191], v[60:63], a[28:31], v[188:191]
    s_waitcnt vmcnt(17)
    s_barrier
    s_waitcnt lgkmcnt(8)
    v_mfma_f32_16x16x32_bf16 v[128:131], v[32:35], a[32:35], v[128:131]
    ds_read_b64_tr_b16 v[48:49], v13 offset:28672
    ds_read_b64_tr_b16 v[64:65], v13 offset:32768
    v_mfma_f32_16x16x32_bf16 v[132:135], v[32:35], a[36:39], v[132:135]
    ds_read_b64_tr_b16 v[66:67], v13 offset:33280
    s_add_u32 m0, s44, 0
    v_mfma_f32_16x16x32_bf16 v[136:139], v[32:35], a[40:43], v[136:139]
    ds_read_b64_tr_b16 v[50:51], v13 offset:29184
    ds_read_b64_tr_b16 v[80:81], v13 offset:33792
    v_mfma_f32_16x16x32_bf16 v[140:143], v[32:35], a[44:47], v[140:143]
    ds_read_b64_tr_b16 v[82:83], v13 offset:34304
    v_mfma_f32_16x16x32_bf16 v[144:147], v[36:39], a[32:35], v[144:147]
    s_waitcnt lgkmcnt(12)
    ds_read_b64_tr_b16 v[52:53], v13 offset:29696
    ds_read_b64_tr_b16 v[96:97], v14 offset:32768
    v_mfma_f32_16x16x32_bf16 v[148:151], v[36:39], a[36:39], v[148:151]
    s_waitcnt lgkmcnt(12)
    ds_read_b64_tr_b16 v[98:99], v14 offset:33280
    v_mfma_f32_16x16x32_bf16 v[152:155], v[36:39], a[40:43], v[152:155]
    ds_read_b64_tr_b16 v[54:55], v13 offset:30208
    s_waitcnt lgkmcnt(12)
    ds_read_b64_tr_b16 v[112:113], v14 offset:33792
    v_mfma_f32_16x16x32_bf16 v[156:159], v[36:39], a[44:47], v[156:159]
    ds_read_b64_tr_b16 v[114:115], v14 offset:34304
    buffer_load_dwordx4 v9, s[20:23], s98 offen lds
    v_mfma_f32_16x16x32_bf16 v[160:163], v[40:43], a[32:35], v[160:163]
    s_waitcnt lgkmcnt(12)
    ds_read_b64_tr_b16 v[56:57], v14 offset:28672
    ds_read_b64_tr_b16 v[68:69], v13 offset:36864
    v_mfma_f32_16x16x32_bf16 v[164:167], v[40:43], a[36:39], v[164:167]
    s_waitcnt lgkmcnt(12)
    ds_read_b64_tr_b16 v[70:71], v13 offset:37376
    v_mfma_f32_16x16x32_bf16 v[168:171], v[40:43], a[40:43], v[168:171]
    ds_read_b64_tr_b16 v[58:59], v14 offset:29184
    s_waitcnt lgkmcnt(12)
    ds_read_b64_tr_b16 v[84:85], v13 offset:37888
    v_mfma_f32_16x16x32_bf16 v[172:175], v[40:43], a[44:47], v[172:175]
    ds_read_b64_tr_b16 v[86:87], v13 offset:38400
    buffer_load_dwordx4 v10, s[20:23], s98 offen offset:1024 lds
    v_mfma_f32_16x16x32_bf16 v[176:179], v[44:47], a[32:35], v[176:179]
    s_waitcnt lgkmcnt(12)
    ds_read_b64_tr_b16 v[60:61], v14 offset:29696
    ds_read_b64_tr_b16 v[100:101], v14 offset:36864
    v_mfma_f32_16x16x32_bf16 v[180:183], v[44:47], a[36:39], v[180:183]
    s_waitcnt lgkmcnt(12)
    ds_read_b64_tr_b16 v[102:103], v14 offset:37376
    v_mfma_f32_16x16x32_bf16 v[184:187], v[44:47], a[40:43], v[184:187]
    ds_read_b64_tr_b16 v[62:63], v14 offset:30208
    s_waitcnt lgkmcnt(12)
    ds_read_b64_tr_b16 v[116:117], v14 offset:37888
    v_mfma_f32_16x16x32_bf16 v[188:191], v[44:47], a[44:47], v[188:191]
    ds_read_b64_tr_b16 v[118:119], v14 offset:38400
    s_waitcnt vmcnt(9)
    s_barrier
    v_mfma_f32_16x16x32_bf16 v[128:131], v[48:51], a[48:51], v[128:131]
    s_waitcnt lgkmcnt(12)
    ds_read_b64_tr_b16 v[72:73], v13 offset:0
    buffer_load_dwordx4 v11, s[20:23], s98 offen offset:2048 lds
    v_mfma_f32_16x16x32_bf16 v[132:135], v[48:51], a[52:55], v[132:135]
    ds_read_b64_tr_b16 v[74:75], v13 offset:512
    v_mfma_f32_16x16x32_bf16 v[136:139], v[48:51], a[56:59], v[136:139]
    s_waitcnt lgkmcnt(12)
    ds_read_b64_tr_b16 v[88:89], v13 offset:1024
    v_mfma_f32_16x16x32_bf16 v[140:143], v[48:51], a[60:63], v[140:143]
    ds_read_b64_tr_b16 v[90:91], v13 offset:1536
    v_mfma_f32_16x16x32_bf16 v[144:147], v[52:55], a[48:51], v[144:147]
    s_waitcnt lgkmcnt(12)
    ds_read_b64_tr_b16 v[104:105], v14 offset:0
    buffer_load_dwordx4 v12, s[20:23], s98 offen offset:3072 lds
    v_mfma_f32_16x16x32_bf16 v[148:151], v[52:55], a[52:55], v[148:151]
    ds_read_b64_tr_b16 v[106:107], v14 offset:512
    s_add_u32 m0, s44, 4096
    v_mfma_f32_16x16x32_bf16 v[152:155], v[52:55], a[56:59], v[152:155]
    s_waitcnt lgkmcnt(12)
    ds_read_b64_tr_b16 v[120:121], v14 offset:1024
    v_mfma_f32_16x16x32_bf16 v[156:159], v[52:55], a[60:63], v[156:159]
    ds_read_b64_tr_b16 v[122:123], v14 offset:1536
    s_xor_b32 s46, s98, 65536
    s_waitcnt lgkmcnt(10)
    v_mfma_f32_16x16x32_bf16 v[160:163], v[56:59], a[48:51], v[160:163]
    ds_read_b64_tr_b16 v[76:77], v13 offset:4096
    ds_read_b64_tr_b16 a[138:139], v19 offset:14336
    v_mfma_f32_16x16x32_bf16 v[164:167], v[56:59], a[52:55], v[164:167]
    ds_read_b64_tr_b16 v[78:79], v13 offset:4608
    buffer_load_dwordx4 v9, s[20:23], s46 offen lds
    v_mfma_f32_16x16x32_bf16 v[168:171], v[56:59], a[56:59], v[168:171]
    ds_read_b64_tr_b16 v[92:93], v13 offset:5120
    v_mfma_f32_16x16x32_bf16 v[172:175], v[56:59], a[60:63], v[172:175]
    s_waitcnt lgkmcnt(12)
    ds_read_b64_tr_b16 v[94:95], v13 offset:5632
    v_mfma_f32_16x16x32_bf16 v[176:179], v[60:63], a[48:51], v[176:179]
    ds_read_b64_tr_b16 v[108:109], v14 offset:4096
    v_mfma_f32_16x16x32_bf16 v[180:183], v[60:63], a[52:55], v[180:183]
    s_waitcnt lgkmcnt(12)
    ds_read_b64_tr_b16 v[110:111], v14 offset:4608
    buffer_load_dwordx4 v10, s[20:23], s46 offen offset:1024 lds
    v_mfma_f32_16x16x32_bf16 v[184:187], v[60:63], a[56:59], v[184:187]
    ds_read_b64_tr_b16 v[124:125], v14 offset:5120
    v_cmp_eq_u32 vcc, 0, v30
    s_and_b32 s47, vcc_lo, 3
    s_cbranch_scc0 L_mkF_ok
    s_mov_b32 s51, 0x40000
L_mkF:
    s_mov_b64 exec, 3
    buffer_load_dword v28, v27, s[32:35], 0 offen sc1
    s_mov_b64 exec, -1
    s_waitcnt vmcnt(0)
    v_cmp_eq_u32 vcc, 0, v28
    s_and_b32 s47, vcc_lo, 3
    s_cbranch_scc0 L_mkF_ok
    s_sub_u32 s51, s51, 1
    s_cmp_lg_u32 s51, 0
    s_cbranch_scc1 L_mkF
L_mkF_ok:
    s_waitcnt vmcnt(7)
    v_mov_b32 v29, s53
    v_mov_b32 v28, s5
    s_mov_b64 exec, 1
    buffer_atomic_or v28, v29, s[24:27], 0 offen offset:0 sc1
    s_mov_b64 exec, -1
    v_mfma_f32_16x16x32_bf16 v[188:191], v[60:63], a[60:63], v[188:191]
    s_waitcnt lgkmcnt(12)
    ds_read_b64_tr_b16 v[126:127], v14 offset:5632
    v_mfma_f32_16x16x32_bf16 v[128:131], v[64:67], a[64:67], v[128:131]
    buffer_load_dwordx4 v11, s[20:23], s46 offen offset:2048 lds
    v_mfma_f32_16x16x32_bf16 v[144:147], v[80:83], a[64:67], v[144:147]
    s_lshr_b32 s58, s95, 18
    s_lshl_b32 s58, s58, 13
    s_add_u32 s88, s58, s52
    v_mfma_f32_16x16x32_bf16 v[160:163], v[96:99], a[64:67], v[160:163]
    buffer_load_dwordx4 v12, s[20:23], s46 offen offset:3072 lds
    v_mfma_f32_16x16x32_bf16 v[176:179], v[112:115], a[64:67], v[176:179]
    s_add_u32 m0, s45, 8192
    v_mfma_f32_16x16x32_bf16 v[128:131], v[68:71], a[80:83], v[128:131]
    s_lshr_b32 s58, s96, 18
    s_lshl_b32 s58, s58, 13
    s_add_u32 s89, s58, s52
    v_mfma_f32_16x16x32_bf16 v[144:147], v[84:87], a[80:83], v[144:147]
    s_lshr_b32 s58, s97, 18
    s_lshl_b32 s58, s58, 13
    s_add_u32 s90, s58, s52
    v_mfma_f32_16x16x32_bf16 v[160:163], v[100:103], a[80:83], v[160:163]
    buffer_load_dwordx4 v9, s[20:23], s99 offen lds
    v_mfma_f32_16x16x32_bf16 v[176:179], v[116:119], a[80:83], v[176:179]
    s_lshr_b32 s58, s98, 18
    s_lshl_b32 s58, s58, 13
    s_add_u32 s91, s58, s52
    v_mfma_f32_16x16x32_bf16 v[128:131], v[72:75], a[96:99], v[128:131]
    s_lshr_b32 s58, s99, 18
    s_lshl_b32 s58, s58, 13
    s_add_u32 s92, s58, s52
    v_mfma_f32_16x16x32_bf16 v[144:147], v[88:91], a[96:99], v[144:147]
    s_waitcnt lgkmcnt(9)
    v_mfma_f32_16x16x32_bf16 v[160:163], v[104:107], a[96:99], v[160:163]
    ds_read_b64_tr_b16 a[140:141], v20 offset:12288
    ds_read_b64_tr_b16 a[142:143], v20 offset:14336
    v_mfma_f32_16x16x32_bf16 v[176:179], v[120:123], a[96:99], v[176:179]
    ds_read_b64_tr_b16 a[144:145], v17 offset:8192
    s_waitcnt lgkmcnt(7)
    v_mfma_f32_16x16x32_bf16 v[128:131], v[76:79], a[112:115], v[128:131]
    buffer_load_dwordx4 v10, s[20:23], s99 offen offset:1024 lds
    v_mfma_f32_16x16x32_bf16 v[144:147], v[92:95], a[112:115], v[144:147]
    ds_read_b64_tr_b16 a[146:147], v17 offset:10240
    s_waitcnt lgkmcnt(4)
    v_mfma_f32_16x16x32_bf16 v[160:163], v[108:111], a[112:115], v[160:163]
    ds_read_b64_tr_b16 a[148:149], v18 offset:8192
    ds_read_b64_tr_b16 a[150:151], v18 offset:10240
    v_mfma_f32_16x16x32_bf16 v[176:179], v[124:127], a[112:115], v[176:179]
    ds_read_b64_tr_b16 a[152:153], v19 offset:8192
    ds_read_b64_tr_b16 a[154:155], v19 offset:10240
    v_mfma_f32_16x16x32_bf16 v[132:135], v[64:67], a[68:71], v[132:135]
    buffer_load_dwordx4 v11, s[20:23], s99 offen offset:2048 lds
    v_mfma_f32_16x16x32_bf16 v[148:151], v[80:83], a[68:71], v[148:151]
    ds_read_b64_tr_b16 a[156:157], v20 offset:8192
    ds_read_b64_tr_b16 a[158:159], v20 offset:10240
    v_mfma_f32_16x16x32_bf16 v[164:167], v[96:99], a[68:71], v[164:167]
    s_waitcnt lgkmcnt(8)
    s_waitcnt vmcnt(12)
    ds_read_b64_tr_b16 a[160:161], v17 offset:16384
    v_mfma_f32_16x16x32_bf16 v[180:183], v[112:115], a[68:71], v[180:183]
    ds_read_b64_tr_b16 a[162:163], v17 offset:18432
    ds_read_b64_tr_b16 a[164:165], v18 offset:16384
    v_mfma_f32_16x16x32_bf16 v[132:135], v[68:71], a[84:87], v[132:135]
    buffer_load_dwordx4 v12, s[20:23], s99 offen offset:3072 lds
    v_mfma_f32_16x16x32_bf16 v[148:151], v[84:87], a[84:87], v[148:151]
    ds_read_b64_tr_b16 a[166:167], v18 offset:18432
    ds_read_b64_tr_b16 a[168:169], v19 offset:16384
    v_mfma_f32_16x16x32_bf16 v[164:167], v[100:103], a[84:87], v[164:167]
    s_add_u32 m0, s44, 12288
    v_mfma_f32_16x16x32_bf16 v[180:183], v[116:119], a[84:87], v[180:183]
    v_pk_mul_f32 v[128:129], v[128:129], v[144:145]
    v_pk_mul_f32 v[130:131], v[130:131], v[146:147]
    v_pk_mul_f32 v[160:161], v[160:161], v[176:177]
    v_mfma_f32_16x16x32_bf16 v[132:135], v[72:75], a[100:103], v[132:135]
    v_pk_mul_f32 v[162:163], v[162:163], v[178:179]
    v_cvt_pk_bf16_f32 v240, v128, v129
    v_cvt_pk_bf16_f32 v241, v130, v131
    v_mfma_f32_16x16x32_bf16 v[148:151], v[88:91], a[100:103], v[148:151]
    s_waitcnt lgkmcnt(5)
    ds_read_b64_tr_b16 a[170:171], v19 offset:18432
    v_cvt_pk_bf16_f32 v242, v160, v161
    v_mfma_f32_16x16x32_bf16 v[164:167], v[104:107], a[100:103], v[164:167]
    buffer_load_dwordx4 v9, s[20:23], s100 offen lds
    v_cvt_pk_bf16_f32 v243, v162, v163
    v_mfma_f32_16x16x32_bf16 v[180:183], v[120:123], a[100:103], v[180:183]
    ds_read_b64_tr_b16 a[172:173], v20 offset:16384
    s_add_u32 s50, s50, 57344
    buffer_store_dwordx4 v[240:243], v25, s[24:27], s50 offen sc1
    v_mfma_f32_16x16x32_bf16 v[132:135], v[76:79], a[116:119], v[132:135]
    ds_read_b64_tr_b16 a[174:175], v20 offset:18432
    v_mfma_f32_16x16x32_bf16 v[148:151], v[92:95], a[116:119], v[148:151]
    buffer_load_dwordx4 v10, s[20:23], s100 offen offset:1024 lds
    v_mfma_f32_16x16x32_bf16 v[164:167], v[108:111], a[116:119], v[164:167]
    s_lshr_b32 s58, s100, 18
    s_lshl_b32 s58, s58, 13
    s_add_u32 s93, s58, s52
    v_mfma_f32_16x16x32_bf16 v[180:183], v[124:127], a[116:119], v[180:183]
    s_lshr_b32 s58, s101, 18
    s_lshl_b32 s58, s58, 13
    s_add_u32 s94, s58, s52
    v_mfma_f32_16x16x32_bf16 v[136:139], v[64:67], a[72:75], v[136:139]
    v_mfma_f32_16x16x32_bf16 v[152:155], v[80:83], a[72:75], v[152:155]
    v_mfma_f32_16x16x32_bf16 v[168:171], v[96:99], a[72:75], v[168:171]
    buffer_load_dwordx4 v11, s[20:23], s100 offen offset:2048 lds
    v_mfma_f32_16x16x32_bf16 v[184:187], v[112:115], a[72:75], v[184:187]
    v_mfma_f32_16x16x32_bf16 v[136:139], v[68:71], a[88:91], v[136:139]
    s_waitcnt lgkmcnt(0)
    v_mfma_f32_16x16x32_bf16 v[152:155], v[84:87], a[88:91], v[152:155]
    v_mfma_f32_16x16x32_bf16 v[168:171], v[100:103], a[88:91], v[168:171]
    buffer_load_dwordx4 v12, s[20:23], s100 offen offset:3072 lds
    v_mfma_f32_16x16x32_bf16 v[184:187], v[116:119], a[88:91], v[184:187]
    v_pk_mul_f32 v[132:133], v[132:133], v[148:149]
    v_pk_mul_f32 v[134:135], v[134:135], v[150:151]
    v_pk_mul_f32 v[164:165], v[164:165], v[180:181]
    v_mfma_f32_16x16x32_bf16 v[136:139], v[72:75], a[104:107], v[136:139]
    s_add_u32 m0, s44, 16384
    v_pk_mul_f32 v[166:167], v[166:167], v[182:183]
    v_cvt_pk_bf16_f32 v244, v132, v133
    v_mfma_f32_16x16x32_bf16 v[152:155], v[88:91], a[104:107], v[152:155]
    v_cvt_pk_bf16_f32 v245, v134, v135
    v_cvt_pk_bf16_f32 v246, v164, v165
    v_cvt_pk_bf16_f32 v247, v166, v167
    v_mfma_f32_16x16x32_bf16 v[168:171], v[104:107], a[104:107], v[168:171]
    buffer_store_dwordx4 v[244:247], v25, s[24:27], s50 offen offset:1024 sc1
    v_mfma_f32_16x16x32_bf16 v[184:187], v[120:123], a[104:107], v[184:187]
    buffer_load_dwordx4 v9, s[20:23], s101 offen lds
    v_mfma_f32_16x16x32_bf16 v[136:139], v[76:79], a[120:123], v[136:139]
    v_mfma_f32_16x16x32_bf16 v[152:155], v[92:95], a[120:123], v[152:155]
    v_mfma_f32_16x16x32_bf16 v[168:171], v[108:111], a[120:123], v[168:171]
    v_mfma_f32_16x16x32_bf16 v[184:187], v[124:127], a[120:123], v[184:187]
    v_mfma_f32_16x16x32_bf16 v[140:143], v[64:67], a[76:79], v[140:143]
    v_mfma_f32_16x16x32_bf16 v[156:159], v[80:83], a[76:79], v[156:159]
    v_mfma_f32_16x16x32_bf16 v[172:175], v[96:99], a[76:79], v[172:175]
    v_mfma_f32_16x16x32_bf16 v[188:191], v[112:115], a[76:79], v[188:191]
    v_mfma_f32_16x16x32_bf16 v[140:143], v[68:71], a[92:95], v[140:143]
    s_mov_b64 exec, 1
    v_mov_b32 v30, 0
    buffer_atomic_add v30, v26, s[24:27], 0 offen sc0 sc1
    s_mov_b64 exec, -1
    v_mfma_f32_16x16x32_bf16 v[156:159], v[84:87], a[92:95], v[156:159]
    v_mfma_f32_16x16x32_bf16 v[172:175], v[100:103], a[92:95], v[172:175]
    v_mfma_f32_16x16x32_bf16 v[188:191], v[116:119], a[92:95], v[188:191]
    v_pk_mul_f32 v[136:137], v[136:137], v[152:153]
    v_pk_mul_f32 v[138:139], v[138:139], v[154:155]
    v_pk_mul_f32 v[168:169], v[168:169], v[184:185]
    v_mfma_f32_16x16x32_bf16 v[140:143], v[72:75], a[108:111], v[140:143]
    v_pk_mul_f32 v[170:171], v[170:171], v[186:187]
    v_cvt_pk_bf16_f32 v248, v136, v137
    v_cvt_pk_bf16_f32 v249, v138, v139
    v_mfma_f32_16x16x32_bf16 v[156:159], v[88:91], a[108:111], v[156:159]
    v_cvt_pk_bf16_f32 v250, v168, v169
    v_cvt_pk_bf16_f32 v251, v170, v171
    buffer_store_dwordx4 v[248:251], v25, s[24:27], s50 offen offset:2048 sc1
    v_mfma_f32_16x16x32_bf16 v[172:175], v[104:107], a[108:111], v[172:175]
    v_mfma_f32_16x16x32_bf16 v[188:191], v[120:123], a[108:111], v[188:191]
    v_mfma_f32_16x16x32_bf16 v[140:143], v[76:79], a[124:127], v[140:143]
    v_mfma_f32_16x16x32_bf16 v[156:159], v[92:95], a[124:127], v[156:159]
    v_mfma_f32_16x16x32_bf16 v[172:175], v[108:111], a[124:127], v[172:175]
    v_mfma_f32_16x16x32_bf16 v[188:191], v[124:127], a[124:127], v[188:191]
    s_nop 7
    v_pk_mul_f32 v[140:141], v[140:141], v[156:157]
    v_pk_mul_f32 v[142:143], v[142:143], v[158:159]
    v_pk_mul_f32 v[172:173], v[172:173], v[188:189]
    v_pk_mul_f32 v[174:175], v[174:175], v[190:191]
    v_cvt_pk_bf16_f32 v252, v140, v141
    v_cvt_pk_bf16_f32 v253, v142, v143
    v_cvt_pk_bf16_f32 v254, v172, v173
    v_cvt_pk_bf16_f32 v255, v174, v175
    buffer_store_dwordx4 v[252:255], v25, s[24:27], s50 offen offset:3072 sc1
    s_barrier
    buffer_load_dwordx4 v10, s[20:23], s101 offen offset:1024 lds
    buffer_load_dwordx4 v11, s[20:23], s101 offen offset:2048 lds
    buffer_load_dwordx4 v12, s[20:23], s101 offen offset:3072 lds
    s_add_u32 m0, s44, 8192
    s_xor_b32 s46, s99, 65536
    buffer_load_dwordx4 v9, s[20:23], s46 offen lds
    buffer_load_dwordx4 v10, s[20:23], s46 offen offset:1024 lds
    buffer_load_dwordx4 v11, s[20:23], s46 offen offset:2048 lds
    buffer_load_dwordx4 v12, s[20:23], s46 offen offset:3072 lds
    s_add_u32 m0, s45, 16384
    s_xor_b32 s46, s100, 65536
    buffer_load_dwordx4 v9, s[20:23], s46 offen lds
    buffer_load_dwordx4 v10, s[20:23], s46 offen offset:1024 lds
    buffer_load_dwordx4 v11, s[20:23], s46 offen offset:2048 lds
    buffer_load_dwordx4 v12, s[20:23], s46 offen offset:3072 lds
    s_add_u32 m0, s45, 24576
    s_xor_b32 s46, s101, 65536
    buffer_load_dwordx4 v9, s[20:23], s46 offen lds
    buffer_load_dwordx4 v10, s[20:23], s46 offen offset:1024 lds
    s_waitcnt vmcnt(13)
    v_mov_b32 v29, s53
    v_mov_b32 v28, s5
    s_mov_b64 exec, 1
    buffer_atomic_or v28, v29, s[24:27], 0 offen offset:1024 sc1
    s_mov_b64 exec, -1
    buffer_load_dwordx4 v11, s[20:23], s46 offen offset:2048 lds
    buffer_load_dwordx4 v12, s[20:23], s46 offen offset:3072 lds
    v_cmp_ne_u32 vcc, 0x7f, v30
    s_and_b32 s47, vcc_lo, 1
    s_cbranch_scc0 L_paF_ok
    s_mov_b32 s51, 0x40000
L_paF:
    s_mov_b64 exec, 1
    v_mov_b32 v28, 0
    buffer_atomic_add v28, v26, s[24:27], 0 offen sc0 sc1
    s_mov_b64 exec, -1
    s_waitcnt vmcnt(0)
    v_cmp_ne_u32 vcc, 0x7f, v28
    s_and_b32 s47, vcc_lo, 1
    s_cbranch_scc0 L_paF_ok
    s_sub_u32 s51, s51, 1
    s_cmp_lg_u32 s51, 0
    s_cbranch_scc1 L_paF
L_paF_ok:
    buffer_load_dwordx4 a[0:3], v21, s[24:27], s88 offen sc1
    buffer_load_dwordx4 a[4:7], v22, s[24:27], s88 offen sc1
    buffer_load_dwordx4 a[8:11], v23, s[24:27], s88 offen sc1
    buffer_load_dwordx4 a[12:15], v24, s[24:27], s88 offen sc1
    buffer_load_dwordx4 a[16:19], v21, s[24:27], s89 offen sc1
    buffer_load_dwordx4 a[20:23], v22, s[24:27], s89 offen sc1
    buffer_load_dwordx4 a[24:27], v23, s[24:27], s89 offen sc1
    buffer_load_dwordx4 a[28:31], v24, s[24:27], s89 offen sc1
    buffer_load_dwordx4 a[32:35], v21, s[24:27], s90 offen sc1
    buffer_load_dwordx4 a[36:39], v22, s[24:27], s90 offen sc1
    s_waitcnt vmcnt(9)
    v_mfma_f32_16x16x32_bf16 v[64:67], v[192:195], a[0:3], 0
    buffer_load_dwordx4 a[40:43], v23, s[24:27], s90 offen sc1
    ds_read_b64_tr_b16 a[176:177], v17 offset:0
    v_mfma_f32_16x16x32_bf16 v[68:71], v[196:199], a[0:3], 0
    buffer_load_dwordx4 a[44:47], v24, s[24:27], s90 offen sc1
    ds_read_b64_tr_b16 a[178:179], v17 offset:2048
    v_mfma_f32_16x16x32_bf16 v[72:75], v[200:203], a[0:3], 0
    ds_read_b64_tr_b16 a[180:181], v18 offset:0
    ds_read_b64_tr_b16 a[182:183], v18 offset:2048
    v_mfma_f32_16x16x32_bf16 v[76:79], v[204:207], a[0:3], 0
    ds_read_b64_tr_b16 a[184:185], v19 offset:0
    ds_read_b64_tr_b16 a[186:187], v19 offset:2048
    s_waitcnt vmcnt(10)
    v_mfma_f32_16x16x32_bf16 v[80:83], v[192:195], a[4:7], 0
    buffer_load_dwordx4 a[48:51], v21, s[24:27], s91 offen sc1
    ds_read_b64_tr_b16 a[188:189], v20 offset:0
    v_mfma_f32_16x16x32_bf16 v[84:87], v[196:199], a[4:7], 0
    buffer_load_dwordx4 a[52:55], v22, s[24:27], s91 offen sc1
    ds_read_b64_tr_b16 a[190:191], v20 offset:2048
    v_mfma_f32_16x16x32_bf16 v[88:91], v[200:203], a[4:7], 0
    v_lshlrev_b32 v25, 4, v0
    s_xor_b32 s58, s36, 1
    s_mul_i32 s58, s58, 20480
    s_add_u32 s58, s58, 81920
    v_add_u32 v5, s58, v25
    s_xor_b32 s58, s36, 2
    s_mul_i32 s58, s58, 20480
    s_add_u32 s58, s58, 86016
    v_add_u32 v6, s58, v25
    s_xor_b32 s58, s36, 3
    s_mul_i32 s58, s58, 20480
    s_add_u32 s58, s58, 90112
    v_add_u32 v7, s58, v25
    v_add_u32 v8, s44, v25
    v_lshrrev_b32 v13, 2, v0
    v_and_b32 v14, 1, v0
    v_lshl_add_u32 v15, v14, 5, v13
    v_bfe_u32 v14, v0, 1, 1
    v_lshl_add_u32 v15, v14, 4, v15
    v_lshlrev_b32 v15, 2, v15
    v_and_b32 v14, 3, v0
    v_lshlrev_b32 v14, 4, v14
    v_lshl_add_u32 v13, v13, 10, v14
    v_mfma_f32_16x16x32_bf16 v[92:95], v[204:207], a[4:7], 0
    s_waitcnt vmcnt(11)
    v_mfma_f32_16x16x32_bf16 v[96:99], v[192:195], a[8:11], 0
    buffer_load_dwordx4 a[56:59], v23, s[24:27], s91 offen sc1
    ds_read_b64_tr_b16 a[208:209], v1 offset:8192
    v_mfma_f32_16x16x32_bf16 v[100:103], v[196:199], a[8:11], 0
    buffer_load_dwordx4 a[60:63], v24, s[24:27], s91 offen sc1
    ds_read_b64_tr_b16 a[210:211], v1 offset:10240
    v_mfma_f32_16x16x32_bf16 v[104:107], v[200:203], a[8:11], 0
    ds_read_b64_tr_b16 a[212:213], v2 offset:8192
    ds_read_b64_tr_b16 a[214:215], v2 offset:10240
    v_mfma_f32_16x16x32_bf16 v[108:111], v[204:207], a[8:11], 0
    ds_read_b64_tr_b16 a[216:217], v3 offset:8192
    ds_read_b64_tr_b16 a[218:219], v3 offset:10240
    s_waitcnt vmcnt(12)
    v_mfma_f32_16x16x32_bf16 v[112:115], v[192:195], a[12:15], 0
    buffer_load_dwordx4 a[64:67], v21, s[24:27], s92 offen sc1
    s_waitcnt lgkmcnt(12)
    ds_read_b64_tr_b16 a[220:221], v4 offset:8192
    v_mfma_f32_16x16x32_bf16 v[116:119], v[196:199], a[12:15], 0
    buffer_load_dwordx4 a[68:71], v22, s[24:27], s92 offen sc1
    ds_read_b64_tr_b16 a[222:223], v4 offset:10240
    v_mfma_f32_16x16x32_bf16 v[120:123], v[200:203], a[12:15], 0
    v_mfma_f32_16x16x32_bf16 v[124:127], v[204:207], a[12:15], 0
    s_waitcnt vmcnt(13)
    v_mfma_f32_16x16x32_bf16 v[64:67], v[208:211], a[16:19], v[64:67]
    buffer_load_dwordx4 a[72:75], v23, s[24:27], s92 offen sc1
    s_waitcnt lgkmcnt(12)
    ds_read_b64_tr_b16 a[224:225], v17 offset:12288
    v_mfma_f32_16x16x32_bf16 v[68:71], v[212:215], a[16:19], v[68:71]
    ds_read_b64_tr_b16 a[226:227], v17 offset:14336
    s_waitcnt lgkmcnt(12)
    ds_read_b64_tr_b16 a[228:229], v18 offset:12288
    v_mfma_f32_16x16x32_bf16 v[72:75], v[216:219], a[16:19], v[72:75]
    ds_read_b64_tr_b16 a[230:231], v18 offset:14336
    s_waitcnt lgkmcnt(12)
    ds_read_b64_tr_b16 a[232:233], v19 offset:12288
    v_mfma_f32_16x16x32_bf16 v[76:79], v[220:223], a[16:19], v[76:79]
    ds_read_b64_tr_b16 a[234:235], v19 offset:14336
    s_waitcnt lgkmcnt(12)
    ds_read_b64_tr_b16 a[236:237], v20 offset:12288
    s_waitcnt vmcnt(13)
    v_mfma_f32_16x16x32_bf16 v[80:83], v[208:211], a[20:23], v[80:83]
    buffer_load_dwordx4 a[76:79], v24, s[24:27], s92 offen sc1
    ds_read_b64_tr_b16 a[238:239], v20 offset:14336
    v_mfma_f32_16x16x32_bf16 v[84:87], v[212:215], a[20:23], v[84:87]
    v_mfma_f32_16x16x32_bf16 v[88:91], v[216:219], a[20:23], v[88:91]
    v_mfma_f32_16x16x32_bf16 v[92:95], v[220:223], a[20:23], v[92:95]
    s_waitcnt vmcnt(13)
    v_mfma_f32_16x16x32_bf16 v[96:99], v[208:211], a[24:27], v[96:99]
    buffer_load_dwordx4 a[80:83], v21, s[24:27], s93 offen sc1
    s_waitcnt lgkmcnt(12)
    ds_read_b64_tr_b16 a[240:241], v17 offset:16384
    v_mfma_f32_16x16x32_bf16 v[100:103], v[212:215], a[24:27], v[100:103]
    ds_read_b64_tr_b16 a[242:243], v17 offset:18432
    s_waitcnt lgkmcnt(12)
    ds_read_b64_tr_b16 a[244:245], v18 offset:16384
    v_mfma_f32_16x16x32_bf16 v[104:107], v[216:219], a[24:27], v[104:107]
    ds_read_b64_tr_b16 a[246:247], v18 offset:18432
    s_waitcnt lgkmcnt(12)
    ds_read_b64_tr_b16 a[248:249], v19 offset:16384
    v_mfma_f32_16x16x32_bf16 v[108:111], v[220:223], a[24:27], v[108:111]
    ds_read_b64_tr_b16 a[250:251], v19 offset:18432
    s_waitcnt lgkmcnt(12)
    ds_read_b64_tr_b16 a[252:253], v20 offset:16384
    s_waitcnt vmcnt(13)
    v_mfma_f32_16x16x32_bf16 v[112:115], v[208:211], a[28:31], v[112:115]
    buffer_load_dwordx4 a[84:87], v22, s[24:27], s93 offen sc1
    ds_read_b64_tr_b16 a[254:255], v20 offset:18432
    v_mfma_f32_16x16x32_bf16 v[116:119], v[212:215], a[28:31], v[116:119]
    v_mfma_f32_16x16x32_bf16 v[120:123], v[216:219], a[28:31], v[120:123]
    v_mfma_f32_16x16x32_bf16 v[124:127], v[220:223], a[28:31], v[124:127]
    s_waitcnt vmcnt(13)
    v_mfma_f32_16x16x32_bf16 v[64:67], v[224:227], a[32:35], v[64:67]
    buffer_load_dwordx4 a[88:91], v23, s[24:27], s93 offen sc1
    s_waitcnt lgkmcnt(12)
    ds_read_b64_tr_b16 a[192:193], v17 offset:4096
    v_mfma_f32_16x16x32_bf16 v[68:71], v[228:231], a[32:35], v[68:71]
    ds_read_b64_tr_b16 a[194:195], v17 offset:6144
    s_waitcnt lgkmcnt(12)
    ds_read_b64_tr_b16 a[196:197], v18 offset:4096
    v_mfma_f32_16x16x32_bf16 v[72:75], v[232:235], a[32:35], v[72:75]
    ds_read_b64_tr_b16 a[198:199], v18 offset:6144
    s_waitcnt lgkmcnt(12)
    ds_read_b64_tr_b16 a[200:201], v19 offset:4096
    v_mfma_f32_16x16x32_bf16 v[76:79], v[236:239], a[32:35], v[76:79]
    ds_read_b64_tr_b16 a[202:203], v19 offset:6144
    s_waitcnt lgkmcnt(12)
    ds_read_b64_tr_b16 a[204:205], v20 offset:4096
    s_waitcnt vmcnt(13)
    v_mfma_f32_16x16x32_bf16 v[80:83], v[224:227], a[36:39], v[80:83]
    buffer_load_dwordx4 a[92:95], v24, s[24:27], s93 offen sc1
    ds_read_b64_tr_b16 a[206:207], v20 offset:6144
    v_mfma_f32_16x16x32_bf16 v[84:87], v[228:231], a[36:39], v[84:87]
    v_mfma_f32_16x16x32_bf16 v[88:91], v[232:235], a[36:39], v[88:91]
    v_mfma_f32_16x16x32_bf16 v[92:95], v[236:239], a[36:39], v[92:95]
    s_waitcnt vmcnt(13)
    v_mfma_f32_16x16x32_bf16 v[96:99], v[224:227], a[40:43], v[96:99]
    buffer_load_dwordx4 a[96:99], v21, s[24:27], s94 offen sc1
    s_waitcnt lgkmcnt(12)
    ds_read_b64_tr_b16 a[112:113], v17 offset:8192
    v_mfma_f32_16x16x32_bf16 v[100:103], v[228:231], a[40:43], v[100:103]
    ds_read_b64_tr_b16 a[114:115], v17 offset:10240
    s_waitcnt lgkmcnt(12)
    ds_read_b64_tr_b16 a[116:117], v18 offset:8192
    v_mfma_f32_16x16x32_bf16 v[104:107], v[232:235], a[40:43], v[104:107]
    ds_read_b64_tr_b16 a[118:119], v18 offset:10240
    s_waitcnt lgkmcnt(12)
    ds_read_b64_tr_b16 a[120:121], v19 offset:8192
    v_mfma_f32_16x16x32_bf16 v[108:111], v[236:239], a[40:43], v[108:111]
    ds_read_b64_tr_b16 a[122:123], v19 offset:10240
    s_waitcnt lgkmcnt(12)
    ds_read_b64_tr_b16 a[124:125], v20 offset:8192
    s_waitcnt vmcnt(13)
    v_mfma_f32_16x16x32_bf16 v[112:115], v[224:227], a[44:47], v[112:115]
    buffer_load_dwordx4 a[100:103], v22, s[24:27], s94 offen sc1
    ds_read_b64_tr_b16 a[126:127], v20 offset:10240
    v_mfma_f32_16x16x32_bf16 v[116:119], v[228:231], a[44:47], v[116:119]
    v_mfma_f32_16x16x32_bf16 v[120:123], v[232:235], a[44:47], v[120:123]
    v_mfma_f32_16x16x32_bf16 v[124:127], v[236:239], a[44:47], v[124:127]
    s_waitcnt vmcnt(13)
    v_mfma_f32_16x16x32_bf16 v[64:67], a[176:179], a[48:51], v[64:67]
    buffer_load_dwordx4 a[104:107], v23, s[24:27], s94 offen sc1
    v_mfma_f32_16x16x32_bf16 v[68:71], a[180:183], a[48:51], v[68:71]
    v_mfma_f32_16x16x32_bf16 v[72:75], a[184:187], a[48:51], v[72:75]
    v_mfma_f32_16x16x32_bf16 v[76:79], a[188:191], a[48:51], v[76:79]
    s_mov_b64 exec, 1
    v_mov_b32 v31, 0
    buffer_atomic_add v31, v26, s[24:27], 0 offen offset:1024 sc0 sc1
    s_mov_b64 exec, -1
    s_waitcnt vmcnt(14)
    v_mfma_f32_16x16x32_bf16 v[80:83], a[176:179], a[52:55], v[80:83]
    buffer_load_dwordx4 a[108:111], v24, s[24:27], s94 offen sc1
    v_mfma_f32_16x16x32_bf16 v[84:87], a[180:183], a[52:55], v[84:87]
    v_mfma_f32_16x16x32_bf16 v[88:91], a[184:187], a[52:55], v[88:91]
    v_mfma_f32_16x16x32_bf16 v[92:95], a[188:191], a[52:55], v[92:95]
    s_waitcnt vmcnt(14)
    v_mfma_f32_16x16x32_bf16 v[96:99], a[176:179], a[56:59], v[96:99]
    v_mfma_f32_16x16x32_bf16 v[100:103], a[180:183], a[56:59], v[100:103]
    v_mfma_f32_16x16x32_bf16 v[104:107], a[184:187], a[56:59], v[104:107]
    v_mfma_f32_16x16x32_bf16 v[108:111], a[188:191], a[56:59], v[108:111]
    s_waitcnt vmcnt(13)
    v_mfma_f32_16x16x32_bf16 v[112:115], a[176:179], a[60:63], v[112:115]
    v_mfma_f32_16x16x32_bf16 v[116:119], a[180:183], a[60:63], v[116:119]
    v_mfma_f32_16x16x32_bf16 v[120:123], a[184:187], a[60:63], v[120:123]
    v_mfma_f32_16x16x32_bf16 v[124:127], a[188:191], a[60:63], v[124:127]
    s_waitcnt vmcnt(12)
    v_mfma_f32_16x16x32_bf16 v[64:67], a[208:211], a[64:67], v[64:67]
    v_mfma_f32_16x16x32_bf16 v[68:71], a[212:215], a[64:67], v[68:71]
    v_mfma_f32_16x16x32_bf16 v[72:75], a[216:219], a[64:67], v[72:75]
    v_mfma_f32_16x16x32_bf16 v[76:79], a[220:223], a[64:67], v[76:79]
    s_waitcnt vmcnt(11)
    v_mfma_f32_16x16x32_bf16 v[80:83], a[208:211], a[68:71], v[80:83]
    s_waitcnt lgkmcnt(12)
    ds_read_b64_tr_b16 a[176:177], v1 offset:16384
    ds_read_b64_tr_b16 a[178:179], v1 offset:18432
    v_mfma_f32_16x16x32_bf16 v[84:87], a[212:215], a[68:71], v[84:87]
    s_waitcnt lgkmcnt(12)
    ds_read_b64_tr_b16 a[180:181], v2 offset:16384
    ds_read_b64_tr_b16 a[182:183], v2 offset:18432
    v_mfma_f32_16x16x32_bf16 v[88:91], a[216:219], a[68:71], v[88:91]
    s_waitcnt lgkmcnt(12)
    ds_read_b64_tr_b16 a[184:185], v3 offset:16384
    ds_read_b64_tr_b16 a[186:187], v3 offset:18432
    v_mfma_f32_16x16x32_bf16 v[92:95], a[220:223], a[68:71], v[92:95]
    s_waitcnt lgkmcnt(12)
    ds_read_b64_tr_b16 a[188:189], v4 offset:16384
    ds_read_b64_tr_b16 a[190:191], v4 offset:18432
    s_waitcnt vmcnt(10)
    v_mfma_f32_16x16x32_bf16 v[96:99], a[208:211], a[72:75], v[96:99]
    v_mfma_f32_16x16x32_bf16 v[100:103], a[212:215], a[72:75], v[100:103]
    v_mfma_f32_16x16x32_bf16 v[104:107], a[216:219], a[72:75], v[104:107]
    v_mfma_f32_16x16x32_bf16 v[108:111], a[220:223], a[72:75], v[108:111]
    s_waitcnt vmcnt(9)
    v_mfma_f32_16x16x32_bf16 v[112:115], a[208:211], a[76:79], v[112:115]
    v_mfma_f32_16x16x32_bf16 v[116:119], a[212:215], a[76:79], v[116:119]
    v_mfma_f32_16x16x32_bf16 v[120:123], a[216:219], a[76:79], v[120:123]
    v_mfma_f32_16x16x32_bf16 v[124:127], a[220:223], a[76:79], v[124:127]
    s_waitcnt vmcnt(1)
    v_cmp_ne_u32 vcc, 0x7f, v31
    s_and_b32 s47, vcc_lo, 1
    s_cbranch_scc0 L_fastBF
    s_mov_b64 exec, 1
    v_mov_b32 v31, 0
    buffer_atomic_add v31, v26, s[24:27], 0 offen offset:1024 sc0 sc1
    s_mov_b64 exec, -1
    v_mfma_f32_16x16x32_bf16 v[64:67], a[224:227], a[80:83], v[64:67]
    v_mfma_f32_16x16x32_bf16 v[68:71], a[228:231], a[80:83], v[68:71]
    v_mfma_f32_16x16x32_bf16 v[72:75], a[232:235], a[80:83], v[72:75]
    v_mfma_f32_16x16x32_bf16 v[76:79], a[236:239], a[80:83], v[76:79]
    v_mfma_f32_16x16x32_bf16 v[80:83], a[224:227], a[84:87], v[80:83]
    s_waitcnt lgkmcnt(12)
    ds_read_b64_tr_b16 a[208:209], v1 offset:24576
    ds_read_b64_tr_b16 a[210:211], v1 offset:26624
    v_mfma_f32_16x16x32_bf16 v[84:87], a[228:231], a[84:87], v[84:87]
    s_waitcnt lgkmcnt(12)
    ds_read_b64_tr_b16 a[212:213], v2 offset:24576
    ds_read_b64_tr_b16 a[214:215], v2 offset:26624
    v_mfma_f32_16x16x32_bf16 v[88:91], a[232:235], a[84:87], v[88:91]
    s_waitcnt lgkmcnt(12)
    ds_read_b64_tr_b16 a[216:217], v3 offset:24576
    ds_read_b64_tr_b16 a[218:219], v3 offset:26624
    v_mfma_f32_16x16x32_bf16 v[92:95], a[236:239], a[84:87], v[92:95]
    s_waitcnt lgkmcnt(12)
    ds_read_b64_tr_b16 a[220:221], v4 offset:24576
    ds_read_b64_tr_b16 a[222:223], v4 offset:26624
    v_mfma_f32_16x16x32_bf16 v[96:99], a[224:227], a[88:91], v[96:99]
    v_mfma_f32_16x16x32_bf16 v[100:103], a[228:231], a[88:91], v[100:103]
    v_mfma_f32_16x16x32_bf16 v[104:107], a[232:235], a[88:91], v[104:107]
    v_mfma_f32_16x16x32_bf16 v[108:111], a[236:239], a[88:91], v[108:111]
    v_mfma_f32_16x16x32_bf16 v[112:115], a[224:227], a[92:95], v[112:115]
    v_mfma_f32_16x16x32_bf16 v[116:119], a[228:231], a[92:95], v[116:119]
    v_mfma_f32_16x16x32_bf16 v[120:123], a[232:235], a[92:95], v[120:123]
    v_mfma_f32_16x16x32_bf16 v[124:127], a[236:239], a[92:95], v[124:127]
    v_mfma_f32_16x16x32_bf16 v[64:67], a[240:243], a[96:99], v[64:67]
    v_mfma_f32_16x16x32_bf16 v[68:71], a[244:247], a[96:99], v[68:71]
    v_mfma_f32_16x16x32_bf16 v[72:75], a[248:251], a[96:99], v[72:75]
    v_mfma_f32_16x16x32_bf16 v[76:79], a[252:255], a[96:99], v[76:79]
    v_mfma_f32_16x16x32_bf16 v[80:83], a[240:243], a[100:103], v[80:83]
    v_mfma_f32_16x16x32_bf16 v[84:87], a[244:247], a[100:103], v[84:87]
    v_mfma_f32_16x16x32_bf16 v[88:91], a[248:251], a[100:103], v[88:91]
    v_mfma_f32_16x16x32_bf16 v[92:95], a[252:255], a[100:103], v[92:95]
    v_mfma_f32_16x16x32_bf16 v[96:99], a[240:243], a[104:107], v[96:99]
    v_mfma_f32_16x16x32_bf16 v[100:103], a[244:247], a[104:107], v[100:103]
    v_mfma_f32_16x16x32_bf16 v[104:107], a[248:251], a[104:107], v[104:107]
    v_mfma_f32_16x16x32_bf16 v[108:111], a[252:255], a[104:107], v[108:111]
    s_waitcnt vmcnt(1)
    v_mfma_f32_16x16x32_bf16 v[112:115], a[240:243], a[108:111], v[112:115]
    v_mfma_f32_16x16x32_bf16 v[116:119], a[244:247], a[108:111], v[116:119]
    v_mfma_f32_16x16x32_bf16 v[120:123], a[248:251], a[108:111], v[120:123]
    v_mfma_f32_16x16x32_bf16 v[124:127], a[252:255], a[108:111], v[124:127]
    s_waitcnt lgkmcnt(0)
    s_waitcnt vmcnt(0)
    v_cmp_ne_u32 vcc, 0x7f, v31
    s_and_b32 s47, vcc_lo, 1
    s_cbranch_scc0 L_pbF_ok
    s_mov_b32 s51, 0x20000
L_pbF:
    s_mov_b64 exec, 1
    v_mov_b32 v28, 0
    buffer_atomic_add v28, v26, s[24:27], 0 offen offset:1024 sc0 sc1
    s_mov_b64 exec, -1
    s_waitcnt vmcnt(0)
    v_cmp_ne_u32 vcc, 0x7f, v28
    s_and_b32 s47, vcc_lo, 1
    s_cbranch_scc0 L_pbF_ok
    s_sub_u32 s51, s51, 1
    s_cmp_lg_u32 s51, 0
    s_cbranch_scc1 L_pbF
L_pbF_ok:
    s_add_u32 s88, s88, 57344
    s_add_u32 s89, s89, 57344
    s_add_u32 s90, s90, 57344
    s_add_u32 s91, s91, 57344
    s_add_u32 s92, s92, 57344
    s_add_u32 s93, s93, 57344
    s_add_u32 s94, s94, 57344
    buffer_load_dwordx4 v[128:131], v22, s[24:27], s88 offen sc1
    buffer_load_dwordx4 v[132:135], v22, s[24:27], s89 offen sc1
    buffer_load_dwordx4 v[136:139], v22, s[24:27], s90 offen sc1
    buffer_load_dwordx4 v[140:143], v22, s[24:27], s91 offen sc1
    buffer_load_dwordx4 v[144:147], v22, s[24:27], s92 offen sc1
    buffer_load_dwordx4 v[148:151], v22, s[24:27], s93 offen sc1
    buffer_load_dwordx4 v[152:155], v22, s[24:27], s94 offen sc1
    buffer_load_dwordx4 v[156:159], v23, s[24:27], s88 offen sc1
    buffer_load_dwordx4 v[160:163], v23, s[24:27], s89 offen sc1
    buffer_load_dwordx4 v[164:167], v23, s[24:27], s90 offen sc1
    buffer_load_dwordx4 v[168:171], v23, s[24:27], s91 offen sc1
    buffer_load_dwordx4 v[172:175], v23, s[24:27], s92 offen sc1
    s_branch L_B
L_fastBF:
    v_mfma_f32_16x16x32_bf16 v[64:67], a[224:227], a[80:83], v[64:67]
    s_add_u32 s88, s88, 57344
    s_add_u32 s89, s89, 57344
    s_add_u32 s90, s90, 57344
    s_add_u32 s91, s91, 57344
    s_add_u32 s92, s92, 57344
    s_add_u32 s93, s93, 57344
    s_add_u32 s94, s94, 57344
    buffer_load_dwordx4 v[128:131], v22, s[24:27], s88 offen sc1
    v_mfma_f32_16x16x32_bf16 v[68:71], a[228:231], a[80:83], v[68:71]
    buffer_load_dwordx4 v[132:135], v22, s[24:27], s89 offen sc1
    v_mfma_f32_16x16x32_bf16 v[72:75], a[232:235], a[80:83], v[72:75]
    v_mfma_f32_16x16x32_bf16 v[76:79], a[236:239], a[80:83], v[76:79]
    v_mfma_f32_16x16x32_bf16 v[80:83], a[224:227], a[84:87], v[80:83]
    buffer_load_dwordx4 v[136:139], v22, s[24:27], s90 offen sc1
    s_waitcnt lgkmcnt(12)
    ds_read_b64_tr_b16 a[208:209], v1 offset:24576
    v_mfma_f32_16x16x32_bf16 v[84:87], a[228:231], a[84:87], v[84:87]
    buffer_load_dwordx4 v[140:143], v22, s[24:27], s91 offen sc1
    ds_read_b64_tr_b16 a[210:211], v1 offset:26624
    v_mfma_f32_16x16x32_bf16 v[88:91], a[232:235], a[84:87], v[88:91]
    s_waitcnt lgkmcnt(12)
    ds_read_b64_tr_b16 a[212:213], v2 offset:24576
    ds_read_b64_tr_b16 a[214:215], v2 offset:26624
    v_mfma_f32_16x16x32_bf16 v[92:95], a[236:239], a[84:87], v[92:95]
    s_waitcnt lgkmcnt(12)
    ds_read_b64_tr_b16 a[216:217], v3 offset:24576
    ds_read_b64_tr_b16 a[218:219], v3 offset:26624
    v_mfma_f32_16x16x32_bf16 v[96:99], a[224:227], a[88:91], v[96:99]
    buffer_load_dwordx4 v[144:147], v22, s[24:27], s92 offen sc1
    s_waitcnt lgkmcnt(12)
    ds_read_b64_tr_b16 a[220:221], v4 offset:24576
    v_mfma_f32_16x16x32_bf16 v[100:103], a[228:231], a[88:91], v[100:103]
    buffer_load_dwordx4 v[148:151], v22, s[24:27], s93 offen sc1
    ds_read_b64_tr_b16 a[222:223], v4 offset:26624
    v_mfma_f32_16x16x32_bf16 v[104:107], a[232:235], a[88:91], v[104:107]
    v_mfma_f32_16x16x32_bf16 v[108:111], a[236:239], a[88:91], v[108:111]
    v_mfma_f32_16x16x32_bf16 v[112:115], a[224:227], a[92:95], v[112:115]
    buffer_load_dwordx4 v[152:155], v22, s[24:27], s94 offen sc1
    v_mfma_f32_16x16x32_bf16 v[116:119], a[228:231], a[92:95], v[116:119]
    buffer_load_dwordx4 v[156:159], v23, s[24:27], s88 offen sc1
    v_mfma_f32_16x16x32_bf16 v[120:123], a[232:235], a[92:95], v[120:123]
    v_mfma_f32_16x16x32_bf16 v[124:127], a[236:239], a[92:95], v[124:127]
    v_mfma_f32_16x16x32_bf16 v[64:67], a[240:243], a[96:99], v[64:67]
    buffer_load_dwordx4 v[160:163], v23, s[24:27], s89 offen sc1
    v_mfma_f32_16x16x32_bf16 v[68:71], a[244:247], a[96:99], v[68:71]
    buffer_load_dwordx4 v[164:167], v23, s[24:27], s90 offen sc1
    v_mfma_f32_16x16x32_bf16 v[72:75], a[248:251], a[96:99], v[72:75]
    v_mfma_f32_16x16x32_bf16 v[76:79], a[252:255], a[96:99], v[76:79]
    v_mfma_f32_16x16x32_bf16 v[80:83], a[240:243], a[100:103], v[80:83]
    buffer_load_dwordx4 v[168:171], v23, s[24:27], s91 offen sc1
    v_mfma_f32_16x16x32_bf16 v[84:87], a[244:247], a[100:103], v[84:87]
    buffer_load_dwordx4 v[172:175], v23, s[24:27], s92 offen sc1
    v_mfma_f32_16x16x32_bf16 v[88:91], a[248:251], a[100:103], v[88:91]
    v_mfma_f32_16x16x32_bf16 v[92:95], a[252:255], a[100:103], v[92:95]
    v_mfma_f32_16x16x32_bf16 v[96:99], a[240:243], a[104:107], v[96:99]
    v_mfma_f32_16x16x32_bf16 v[100:103], a[244:247], a[104:107], v[100:103]
    v_mfma_f32_16x16x32_bf16 v[104:107], a[248:251], a[104:107], v[104:107]
    v_mfma_f32_16x16x32_bf16 v[108:111], a[252:255], a[104:107], v[108:111]
    s_waitcnt vmcnt(12)
    v_mfma_f32_16x16x32_bf16 v[112:115], a[240:243], a[108:111], v[112:115]
    v_mfma_f32_16x16x32_bf16 v[116:119], a[244:247], a[108:111], v[116:119]
    v_mfma_f32_16x16x32_bf16 v[120:123], a[248:251], a[108:111], v[120:123]
    v_mfma_f32_16x16x32_bf16 v[124:127], a[252:255], a[108:111], v[124:127]
    s_waitcnt lgkmcnt(0)
    s_branch L_B
L_spare:
    s_lshl_b32 s39, s55, 2
    s_add_u32 s39, s39, s57
    s_xor_b32 s40, s56, 3
    v_xor_b32 v6, 128, v5
    v_xor_b32 v8, 128, v7
    s_lshr_b32 s58, s36, 1
    s_lshl_b32 s58, s58, 17
    s_and_b32 s59, s36, 1
    s_lshl_b32 s59, s59, 15
    s_add_u32 s58, s58, s59
    v_lshlrev_b32 v246, 5, v242
    v_xor_b32 v246, v245, v246
    v_lshl_add_u32 v9, v240, 10, v246
    v_add_u32 v9, s58, v9
    v_add_u32 v10, 7168, v9
    v_add_u32 v11, 14336, v9
    v_add_u32 v12, 21504, v9
    s_mul_i32 s44, s36, 20480
    s_add_u32 s44, s44, 81920
    s_lshl_b32 s43, s40, 7
    s_mov_b32 s22, 1835008
    s_mov_b32 s23, 0x20000
    s_mov_b32 s26, 268435456
    s_mov_b32 s27, 0x20000
    s_mov_b32 s30, 2097152
    s_mov_b32 s31, 0x20000
    s_mov_b32 s34, 256
    s_mov_b32 s35, 0x20000
    s_cmp_lg_u32 s36, 0
    s_cbranch_scc1 L_sp1
    s_lshl_b32 s58, s39, 13
    s_add_u32 s58, s58, 16777216
    v_lshlrev_b32 v240, 10, v0
    v_mov_b32 v241, 0
    s_mov_b64 exec, 0xff
    buffer_store_dword v241, v240, s[24:27], s58 offen sc1
    s_mov_b64 exec, -1
L_sp1:
    s_bfe_u32 s46, s6, 196620
    s_lshl_b32 s58, s57, 2
    s_add_u32 s58, s58, s36
    s_lshr_b32 s59, s55, 1
    s_lshl_b32 s59, s59, 4
    s_add_u32 s59, s59, s58
    s_lshl_b32 s59, s59, 15
    s_lshl_b32 s47, s46, 7
    s_add_u32 s59, s59, s47
    v_lshlrev_b32 v244, 10, v0
    s_mov_b32 exec_hi, 0
    buffer_load_dword v253, v244, s[8:11], s59 offen
    s_mov_b64 exec, -1
    s_bfe_u32 s46, s6, 196624
    s_lshl_b32 s58, s57, 2
    s_add_u32 s58, s58, s36
    s_lshr_b32 s59, s55, 1
    s_lshl_b32 s59, s59, 4
    s_add_u32 s59, s59, s58
    s_lshl_b32 s59, s59, 15
    s_lshl_b32 s47, s46, 7
    s_add_u32 s59, s59, s47
    v_lshlrev_b32 v244, 10, v0
    s_mov_b32 exec_hi, 0
    buffer_load_dword v253, v244, s[8:11], s59 offen
    s_mov_b64 exec, -1
    v_min_u32 v240, 55, v0
    s_lshl_b32 s58, s39, 2
    s_add_u32 s58, s58, s36
    s_and_b32 s59, s58, 63
    s_lshr_b32 s58, s58, 6
    s_lshl_b32 s58, s58, 7
    s_add_u32 s58, s58, s59
    s_lshl_b32 s58, s58, 10
    v_lshrrev_b32 v242, 3, v240
    v_lshlrev_b32 v242, 18, v242
    v_and_b32 v247, 7, v240
    v_lshl_add_u32 v242, v247, 7, v242
    buffer_load_dword v249, v242, s[20:23], s58 offen
    s_add_u32 s58, s58, 65536
    buffer_load_dword v250, v242, s[20:23], s58 offen
    s_waitcnt vmcnt(4)
    s_cmp_lg_u32 s36, 0
    s_cbranch_scc1 L_sp2
    s_lshl_b32 s58, s39, 2
    v_mov_b32 v247, s58
    v_mov_b32 v248, 1
    s_mov_b64 exec, 1
    buffer_store_dword v248, v247, s[32:35], 0 offen sc1
    s_mov_b64 exec, -1
L_sp2:
    v_lshrrev_b32 v240, 5, v0
    v_bfe_u32 v241, v0, 4, 1
    v_bfe_u32 v242, v0, 2, 2
    v_and_b32 v243, 3, v0
    v_bfe_u32 v244, v0, 3, 1
    v_lshlrev_b32 v243, 3, v243
    v_lshl_add_u32 v243, v242, 7, v243
    v_lshl_or_b32 v245, v241, 1, v244
    v_lshl_add_u32 v243, v245, 5, v243
    v_mul_u32_u24 v13, 40960, v241
    v_lshl_add_u32 v13, v240, 11, v13
    v_add_u32 v13, v13, v243
    s_and_b32 s58, s36, 1
    s_lshl_b32 s58, s58, 6
    v_xor_b32 v13, s58, v13
    v_xor_b32 v14, 32, v13
    v_lshrrev_b32 v246, 4, v0
    v_lshl_add_u32 v245, v246, 9, v243
    v_add_u32 v17, s44, v245
    v_xor_b32 v18, 32, v17
    v_xor_b32 v19, 64, v17
    v_xor_b32 v20, 96, v17
    v_and_b32 v245, 15, v0
    v_bfe_u32 v247, v0, 1, 3
    v_xor_b32 v247, v247, v246
    v_lshlrev_b32 v247, 4, v247
    v_lshl_add_u32 v245, v245, 7, v247
    s_lshr_b32 s58, s36, 1
    s_mul_i32 s58, s58, 40960
    s_add_u32 s58, s58, 81920
    v_add_u32 v15, s58, v245
    v_xor_b32 v16, 64, v15
    s_add_u32 s58, s39, s36
    v_lshlrev_b32 v21, 4, v0
    s_and_b32 s58, s58, 3
    s_cmp_eq_u32 s58, 3
    s_cselect_b32 s58, 4, s58
    s_lshl_b32 s58, s58, 7
    s_add_u32 s58, s58, 3712
    s_mov_b32 exec_lo, 0xff000000
    s_mov_b32 exec_hi, 0
    v_add_u32 v21, s58, v21
    s_mov_b64 exec, -1
    s_lshl_b32 s58, s36, 10
    v_add_u32 v21, s58, v21
    v_xor_b32 v22, 1024, v21
    v_xor_b32 v23, 2048, v21
    v_xor_b32 v24, 3072, v21
    s_mul_i32 s52, s39, 458752
    s_mul_i32 s58, s36, 114688
    s_add_u32 s52, s52, s58
    v_add_u32 v26, 5, v0
    v_lshrrev_b32 v26, 3, v26
    v_add_u32 v26, v26, v0
    v_min_u32 v26, 7, v26
    v_lshlrev_b32 v26, 7, v26
    s_lshl_b32 s58, s39, 13
    s_lshl_b32 s59, s36, 11
    s_add_u32 s58, s58, s59
    s_add_u32 s58, s58, 16777216
    v_add_u32 v26, s58, v26
    s_and_b32 s58, s57, 1
    s_lshl_b32 s58, s58, 2
    s_lshl_b32 s58, s57, 1
    s_add_u32 s58, s58, s56
    s_sub_u32 s59, s58, 7
    s_cmp_ge_u32 s58, 7
    s_cselect_b32 s58, s59, s58
    s_lshl_b32 s59, s58, 18
    s_add_u32 s95, s59, s43
    s_add_u32 s58, s58, 1
    s_cmp_eq_u32 s58, 7
    s_cselect_b32 s58, 0, s58
    s_lshl_b32 s59, s58, 18
    s_add_u32 s96, s59, s43
    s_add_u32 s58, s58, 1
    s_cmp_eq_u32 s58, 7
    s_cselect_b32 s58, 0, s58
    s_lshl_b32 s59, s58, 18
    s_add_u32 s97, s59, s43
    s_add_u32 s58, s58, 1
    s_cmp_eq_u32 s58, 7
    s_cselect_b32 s58, 0, s58
    s_lshl_b32 s59, s58, 18
    s_add_u32 s98, s59, s43
    s_add_u32 s58, s58, 1
    s_cmp_eq_u32 s58, 7
    s_cselect_b32 s58, 0, s58
    s_lshl_b32 s59, s58, 18
    s_add_u32 s99, s59, s43
    s_add_u32 s58, s58, 1
    s_cmp_eq_u32 s58, 7
    s_cselect_b32 s58, 0, s58
    s_lshl_b32 s59, s58, 18
    s_add_u32 s100, s59, s43
    s_add_u32 s58, s58, 1
    s_cmp_eq_u32 s58, 7
    s_cselect_b32 s58, 0, s58
    s_lshl_b32 s59, s58, 18
    s_add_u32 s101, s59, s43
    s_lshl_b32 s58, s39, 16
    s_lshl_b32 s59, s36, 14
    s_add_u32 s58, s58, s59
    s_add_u32 s54, s58, s43
    s_lshr_b32 s58, s95, 18
    s_lshl_b32 s58, s58, 13
    s_add_u32 s88, s58, s52
    s_lshr_b32 s58, s96, 18
    s_lshl_b32 s58, s58, 13
    s_add_u32 s89, s58, s52
    s_lshr_b32 s58, s97, 18
    s_lshl_b32 s58, s58, 13
    s_add_u32 s90, s58, s52
    s_lshr_b32 s58, s98, 18
    s_lshl_b32 s58, s58, 13
    s_add_u32 s91, s58, s52
    s_lshr_b32 s58, s99, 18
    s_lshl_b32 s58, s58, 13
    s_add_u32 s92, s58, s52
    s_lshr_b32 s58, s100, 18
    s_lshl_b32 s58, s58, 13
    s_add_u32 s93, s58, s52
    s_lshr_b32 s58, s101, 18
    s_lshl_b32 s58, s58, 13
    s_add_u32 s94, s58, s52
    s_add_u32 m0, s44, 16384
    s_nop 0
    buffer_load_dwordx4 v9, s[20:23], s95 offen lds
    s_waitcnt vmcnt(4)
    buffer_load_dwordx4 v10, s[20:23], s95 offen offset:1024 lds
    s_waitcnt vmcnt(4)
    buffer_load_dwordx4 v11, s[20:23], s95 offen offset:2048 lds
    s_waitcnt vmcnt(4)
    buffer_load_dwordx4 v12, s[20:23], s95 offen offset:3072 lds
    s_waitcnt vmcnt(4)
    s_add_u32 m0, s44, 12288
    s_nop 0
    buffer_load_dwordx4 v9, s[20:23], s96 offen lds
    s_waitcnt vmcnt(4)
    buffer_load_dwordx4 v10, s[20:23], s96 offen offset:1024 lds
    s_waitcnt vmcnt(4)
    buffer_load_dwordx4 v11, s[20:23], s96 offen offset:2048 lds
    s_waitcnt vmcnt(4)
    buffer_load_dwordx4 v12, s[20:23], s96 offen offset:3072 lds
    s_waitcnt vmcnt(4)
    ds_read_b64_tr_b16 v[192:193], v17 offset:16384
    ds_read_b64_tr_b16 v[194:195], v17 offset:18432
    ds_read_b64_tr_b16 v[196:197], v18 offset:16384
    ds_read_b64_tr_b16 v[198:199], v18 offset:18432
    ds_read_b64_tr_b16 v[200:201], v19 offset:16384
    ds_read_b64_tr_b16 v[202:203], v19 offset:18432
    ds_read_b64_tr_b16 v[204:205], v20 offset:16384
    ds_read_b64_tr_b16 v[206:207], v20 offset:18432
    s_waitcnt lgkmcnt(0)
    s_add_u32 m0, s44, 16384
    s_nop 0
    buffer_load_dwordx4 v9, s[20:23], s97 offen lds
    s_waitcnt vmcnt(4)
    buffer_load_dwordx4 v10, s[20:23], s97 offen offset:1024 lds
    s_waitcnt vmcnt(4)
    buffer_load_dwordx4 v11, s[20:23], s97 offen offset:2048 lds
    s_waitcnt vmcnt(4)
    buffer_load_dwordx4 v12, s[20:23], s97 offen offset:3072 lds
    s_waitcnt vmcnt(4)
    ds_read_b64_tr_b16 v[208:209], v17 offset:12288
    ds_read_b64_tr_b16 v[210:211], v17 offset:14336
    ds_read_b64_tr_b16 v[212:213], v18 offset:12288
    ds_read_b64_tr_b16 v[214:215], v18 offset:14336
    ds_read_b64_tr_b16 v[216:217], v19 offset:12288
    ds_read_b64_tr_b16 v[218:219], v19 offset:14336
    ds_read_b64_tr_b16 v[220:221], v20 offset:12288
    ds_read_b64_tr_b16 v[222:223], v20 offset:14336
    s_waitcnt lgkmcnt(0)
    s_add_u32 m0, s44, 12288
    s_xor_b32 s46, s95, 65536
    buffer_load_dwordx4 v9, s[20:23], s46 offen lds
    s_waitcnt vmcnt(4)
    buffer_load_dwordx4 v10, s[20:23], s46 offen offset:1024 lds
    s_waitcnt vmcnt(4)
    buffer_load_dwordx4 v11, s[20:23], s46 offen offset:2048 lds
    s_waitcnt vmcnt(4)
    buffer_load_dwordx4 v12, s[20:23], s46 offen offset:3072 lds
    s_waitcnt vmcnt(4)
    ds_read_b64_tr_b16 v[224:225], v17 offset:16384
    ds_read_b64_tr_b16 v[226:227], v17 offset:18432
    ds_read_b64_tr_b16 v[228:229], v18 offset:16384
    ds_read_b64_tr_b16 v[230:231], v18 offset:18432
    ds_read_b64_tr_b16 v[232:233], v19 offset:16384
    ds_read_b64_tr_b16 v[234:235], v19 offset:18432
    ds_read_b64_tr_b16 v[236:237], v20 offset:16384
    ds_read_b64_tr_b16 v[238:239], v20 offset:18432
    s_waitcnt lgkmcnt(0)
    s_add_u32 m0, s44, 16384
    s_xor_b32 s46, s96, 65536
    buffer_load_dwordx4 v9, s[20:23], s46 offen lds
    s_waitcnt vmcnt(4)
    buffer_load_dwordx4 v10, s[20:23], s46 offen offset:1024 lds
    s_waitcnt vmcnt(4)
    buffer_load_dwordx4 v11, s[20:23], s46 offen offset:2048 lds
    s_waitcnt vmcnt(4)
    buffer_load_dwordx4 v12, s[20:23], s46 offen offset:3072 lds
    s_waitcnt vmcnt(4)
    ds_read_b64_tr_b16 a[128:129], v17 offset:12288
    ds_read_b64_tr_b16 a[130:131], v17 offset:14336
    ds_read_b64_tr_b16 a[132:133], v18 offset:12288
    ds_read_b64_tr_b16 a[134:135], v18 offset:14336
    ds_read_b64_tr_b16 a[136:137], v19 offset:12288
    ds_read_b64_tr_b16 a[138:139], v19 offset:14336
    ds_read_b64_tr_b16 a[140:141], v20 offset:12288
    ds_read_b64_tr_b16 a[142:143], v20 offset:14336
    s_waitcnt lgkmcnt(0)
    s_add_u32 m0, s44, 12288
    s_xor_b32 s46, s97, 65536
    buffer_load_dwordx4 v9, s[20:23], s46 offen lds
    s_waitcnt vmcnt(4)
    buffer_load_dwordx4 v10, s[20:23], s46 offen offset:1024 lds
    s_waitcnt vmcnt(4)
    buffer_load_dwordx4 v11, s[20:23], s46 offen offset:2048 lds
    s_waitcnt vmcnt(4)
    buffer_load_dwordx4 v12, s[20:23], s46 offen offset:3072 lds
    s_waitcnt vmcnt(4)
    ds_read_b64_tr_b16 a[144:145], v17 offset:16384
    ds_read_b64_tr_b16 a[146:147], v17 offset:18432
    ds_read_b64_tr_b16 a[148:149], v18 offset:16384
    ds_read_b64_tr_b16 a[150:151], v18 offset:18432
    ds_read_b64_tr_b16 a[152:153], v19 offset:16384
    ds_read_b64_tr_b16 a[154:155], v19 offset:18432
    ds_read_b64_tr_b16 a[156:157], v20 offset:16384
    ds_read_b64_tr_b16 a[158:159], v20 offset:18432
    s_waitcnt lgkmcnt(0)
    s_add_u32 m0, s44, 16384
    s_nop 0
    buffer_load_dwordx4 v9, s[20:23], s98 offen lds
    s_waitcnt vmcnt(4)
    buffer_load_dwordx4 v10, s[20:23], s98 offen offset:1024 lds
    s_waitcnt vmcnt(4)
    buffer_load_dwordx4 v11, s[20:23], s98 offen offset:2048 lds
    s_waitcnt vmcnt(4)
    buffer_load_dwordx4 v12, s[20:23], s98 offen offset:3072 lds
    s_waitcnt vmcnt(4)
    ds_read_b64_tr_b16 a[160:161], v17 offset:12288
    ds_read_b64_tr_b16 a[162:163], v17 offset:14336
    ds_read_b64_tr_b16 a[164:165], v18 offset:12288
    ds_read_b64_tr_b16 a[166:167], v18 offset:14336
    ds_read_b64_tr_b16 a[168:169], v19 offset:12288
    ds_read_b64_tr_b16 a[170:171], v19 offset:14336
    ds_read_b64_tr_b16 a[172:173], v20 offset:12288
    ds_read_b64_tr_b16 a[174:175], v20 offset:14336
    s_waitcnt lgkmcnt(0)
    s_add_u32 m0, s44, 12288
    s_xor_b32 s46, s98, 65536
    buffer_load_dwordx4 v9, s[20:23], s46 offen lds
    s_waitcnt vmcnt(4)
    buffer_load_dwordx4 v10, s[20:23], s46 offen offset:1024 lds
    s_waitcnt vmcnt(4)
    buffer_load_dwordx4 v11, s[20:23], s46 offen offset:2048 lds
    s_waitcnt vmcnt(4)
    buffer_load_dwordx4 v12, s[20:23], s46 offen offset:3072 lds
    s_waitcnt vmcnt(4)
    ds_read_b64_tr_b16 a[176:177], v17 offset:16384
    ds_read_b64_tr_b16 a[178:179], v17 offset:18432
    ds_read_b64_tr_b16 a[180:181], v18 offset:16384
    ds_read_b64_tr_b16 a[182:183], v18 offset:18432
    ds_read_b64_tr_b16 a[184:185], v19 offset:16384
    ds_read_b64_tr_b16 a[186:187], v19 offset:18432
    ds_read_b64_tr_b16 a[188:189], v20 offset:16384
    ds_read_b64_tr_b16 a[190:191], v20 offset:18432
    s_waitcnt lgkmcnt(0)
    s_add_u32 m0, s44, 16384
    s_nop 0
    buffer_load_dwordx4 v9, s[20:23], s99 offen lds
    s_waitcnt vmcnt(4)
    buffer_load_dwordx4 v10, s[20:23], s99 offen offset:1024 lds
    s_waitcnt vmcnt(4)
    buffer_load_dwordx4 v11, s[20:23], s99 offen offset:2048 lds
    s_waitcnt vmcnt(4)
    buffer_load_dwordx4 v12, s[20:23], s99 offen offset:3072 lds
    s_waitcnt vmcnt(4)
    ds_read_b64_tr_b16 a[192:193], v17 offset:12288
    ds_read_b64_tr_b16 a[194:195], v17 offset:14336
    ds_read_b64_tr_b16 a[196:197], v18 offset:12288
    ds_read_b64_tr_b16 a[198:199], v18 offset:14336
    ds_read_b64_tr_b16 a[200:201], v19 offset:12288
    ds_read_b64_tr_b16 a[202:203], v19 offset:14336
    ds_read_b64_tr_b16 a[204:205], v20 offset:12288
    ds_read_b64_tr_b16 a[206:207], v20 offset:14336
    s_waitcnt lgkmcnt(0)
    s_add_u32 m0, s44, 12288
    s_nop 0
    buffer_load_dwordx4 v9, s[20:23], s100 offen lds
    s_waitcnt vmcnt(4)
    buffer_load_dwordx4 v10, s[20:23], s100 offen offset:1024 lds
    s_waitcnt vmcnt(4)
    buffer_load_dwordx4 v11, s[20:23], s100 offen offset:2048 lds
    s_waitcnt vmcnt(4)
    buffer_load_dwordx4 v12, s[20:23], s100 offen offset:3072 lds
    s_waitcnt vmcnt(4)
    ds_read_b64_tr_b16 a[208:209], v17 offset:16384
    ds_read_b64_tr_b16 a[210:211], v17 offset:18432
    ds_read_b64_tr_b16 a[212:213], v18 offset:16384
    ds_read_b64_tr_b16 a[214:215], v18 offset:18432
    ds_read_b64_tr_b16 a[216:217], v19 offset:16384
    ds_read_b64_tr_b16 a[218:219], v19 offset:18432
    ds_read_b64_tr_b16 a[220:221], v20 offset:16384
    ds_read_b64_tr_b16 a[222:223], v20 offset:18432
    s_waitcnt lgkmcnt(0)
    s_add_u32 m0, s44, 16384
    s_nop 0
    buffer_load_dwordx4 v9, s[20:23], s101 offen lds
    s_waitcnt vmcnt(4)
    buffer_load_dwordx4 v10, s[20:23], s101 offen offset:1024 lds
    s_waitcnt vmcnt(4)
    buffer_load_dwordx4 v11, s[20:23], s101 offen offset:2048 lds
    s_waitcnt vmcnt(4)
    buffer_load_dwordx4 v12, s[20:23], s101 offen offset:3072 lds
    s_waitcnt vmcnt(4)
    ds_read_b64_tr_b16 a[224:225], v17 offset:12288
    ds_read_b64_tr_b16 a[226:227], v17 offset:14336
    ds_read_b64_tr_b16 a[228:229], v18 offset:12288
    ds_read_b64_tr_b16 a[230:231], v18 offset:14336
    ds_read_b64_tr_b16 a[232:233], v19 offset:12288
    ds_read_b64_tr_b16 a[234:235], v19 offset:14336
    ds_read_b64_tr_b16 a[236:237], v20 offset:12288
    ds_read_b64_tr_b16 a[238:239], v20 offset:14336
    s_waitcnt lgkmcnt(0)
    s_add_u32 m0, s44, 12288
    s_xor_b32 s46, s99, 65536
    buffer_load_dwordx4 v9, s[20:23], s46 offen lds
    s_waitcnt vmcnt(4)
    buffer_load_dwordx4 v10, s[20:23], s46 offen offset:1024 lds
    s_waitcnt vmcnt(4)
    buffer_load_dwordx4 v11, s[20:23], s46 offen offset:2048 lds
    s_waitcnt vmcnt(4)
    buffer_load_dwordx4 v12, s[20:23], s46 offen offset:3072 lds
    s_waitcnt vmcnt(4)
    ds_read_b64_tr_b16 a[240:241], v17 offset:16384
    ds_read_b64_tr_b16 a[242:243], v17 offset:18432
    ds_read_b64_tr_b16 a[244:245], v18 offset:16384
    ds_read_b64_tr_b16 a[246:247], v18 offset:18432
    ds_read_b64_tr_b16 a[248:249], v19 offset:16384
    ds_read_b64_tr_b16 a[250:251], v19 offset:18432
    ds_read_b64_tr_b16 a[252:253], v20 offset:16384
    ds_read_b64_tr_b16 a[254:255], v20 offset:18432
    s_waitcnt lgkmcnt(0)
    s_add_u32 m0, s44, 0
    s_xor_b32 s46, s100, 65536
    buffer_load_dwordx4 v9, s[20:23], s46 offen lds
    s_waitcnt vmcnt(4)
    buffer_load_dwordx4 v10, s[20:23], s46 offen offset:1024 lds
    s_waitcnt vmcnt(4)
    buffer_load_dwordx4 v11, s[20:23], s46 offen offset:2048 lds
    s_waitcnt vmcnt(4)
    buffer_load_dwordx4 v12, s[20:23], s46 offen offset:3072 lds
    s_waitcnt vmcnt(4)
    ds_read_b64_tr_b16 a[112:113], v17 offset:12288
    ds_read_b64_tr_b16 a[114:115], v17 offset:14336
    ds_read_b64_tr_b16 a[116:117], v18 offset:12288
    ds_read_b64_tr_b16 a[118:119], v18 offset:14336
    ds_read_b64_tr_b16 a[120:121], v19 offset:12288
    ds_read_b64_tr_b16 a[122:123], v19 offset:14336
    ds_read_b64_tr_b16 a[124:125], v20 offset:12288
    ds_read_b64_tr_b16 a[126:127], v20 offset:14336
    s_waitcnt lgkmcnt(0)
    s_add_u32 m0, s44, 4096
    s_xor_b32 s46, s101, 65536
    buffer_load_dwordx4 v9, s[20:23], s46 offen lds
    s_waitcnt vmcnt(4)
    buffer_load_dwordx4 v10, s[20:23], s46 offen offset:1024 lds
    s_waitcnt vmcnt(4)
    buffer_load_dwordx4 v11, s[20:23], s46 offen offset:2048 lds
    s_waitcnt vmcnt(4)
    buffer_load_dwordx4 v12, s[20:23], s46 offen offset:3072 lds
    s_waitcnt vmcnt(4)
    s_lshl_b32 s58, s39, 2
    v_mov_b32 v27, s58
    s_waitcnt vmcnt(0)
    s_barrier
    s_mov_b32 s51, 0x40000
L_spa:
    s_mov_b64 exec, 1
    v_mov_b32 v28, 0
    buffer_atomic_add v28, v26, s[24:27], 0 offen sc0 sc1
    s_mov_b64 exec, -1
    s_waitcnt vmcnt(0)
    v_cmp_ne_u32 vcc, 0x7f, v28
    s_and_b32 s47, vcc_lo, 1
    s_cbranch_scc0 L_spa_ok
    s_sub_u32 s51, s51, 1
    s_cmp_lg_u32 s51, 0
    s_cbranch_scc1 L_spa
L_spa_ok:
    buffer_load_dwordx4 a[0:3], v21, s[24:27], s88 offen sc1
    buffer_load_dwordx4 a[4:7], v22, s[24:27], s88 offen sc1
    buffer_load_dwordx4 a[8:11], v23, s[24:27], s88 offen sc1
    buffer_load_dwordx4 a[12:15], v24, s[24:27], s88 offen sc1
    buffer_load_dwordx4 a[16:19], v21, s[24:27], s89 offen sc1
    buffer_load_dwordx4 a[20:23], v22, s[24:27], s89 offen sc1
    buffer_load_dwordx4 a[24:27], v23, s[24:27], s89 offen sc1
    buffer_load_dwordx4 a[28:31], v24, s[24:27], s89 offen sc1
    buffer_load_dwordx4 a[32:35], v21, s[24:27], s90 offen sc1
    buffer_load_dwordx4 a[36:39], v22, s[24:27], s90 offen sc1
    buffer_load_dwordx4 a[40:43], v23, s[24:27], s90 offen sc1
    buffer_load_dwordx4 a[44:47], v24, s[24:27], s90 offen sc1
    s_waitcnt vmcnt(11)
    v_mfma_f32_16x16x32_bf16 v[64:67], v[192:195], a[0:3], 0
    buffer_load_dwordx4 a[48:51], v21, s[24:27], s91 offen sc1
    v_mfma_f32_16x16x32_bf16 v[68:71], v[196:199], a[0:3], 0
    buffer_load_dwordx4 a[52:55], v22, s[24:27], s91 offen sc1
    v_mfma_f32_16x16x32_bf16 v[72:75], v[200:203], a[0:3], 0
    v_lshlrev_b32 v25, 4, v0
    s_xor_b32 s58, s36, 1
    s_mul_i32 s58, s58, 20480
    s_add_u32 s58, s58, 81920
    v_add_u32 v5, s58, v25
    s_xor_b32 s58, s36, 2
    s_mul_i32 s58, s58, 20480
    s_add_u32 s58, s58, 86016
    v_add_u32 v6, s58, v25
    s_xor_b32 s58, s36, 3
    s_mul_i32 s58, s58, 20480
    s_add_u32 s58, s58, 90112
    v_add_u32 v7, s58, v25
    v_add_u32 v8, s44, v25
    v_lshrrev_b32 v13, 2, v0
    v_and_b32 v14, 1, v0
    v_lshl_add_u32 v15, v14, 5, v13
    v_bfe_u32 v14, v0, 1, 1
    v_lshl_add_u32 v15, v14, 4, v15
    v_lshlrev_b32 v15, 2, v15
    v_and_b32 v14, 3, v0
    v_lshlrev_b32 v14, 4, v14
    v_lshl_add_u32 v13, v13, 10, v14
    v_mfma_f32_16x16x32_bf16 v[76:79], v[204:207], a[0:3], 0
    s_waitcnt vmcnt(12)
    v_mfma_f32_16x16x32_bf16 v[80:83], v[192:195], a[4:7], 0
    buffer_load_dwordx4 a[56:59], v23, s[24:27], s91 offen sc1
    v_mfma_f32_16x16x32_bf16 v[84:87], v[196:199], a[4:7], 0
    buffer_load_dwordx4 a[60:63], v24, s[24:27], s91 offen sc1
    v_mfma_f32_16x16x32_bf16 v[88:91], v[200:203], a[4:7], 0
    v_mfma_f32_16x16x32_bf16 v[92:95], v[204:207], a[4:7], 0
    s_waitcnt vmcnt(13)
    v_mfma_f32_16x16x32_bf16 v[96:99], v[192:195], a[8:11], 0
    buffer_load_dwordx4 a[64:67], v21, s[24:27], s92 offen sc1
    v_mfma_f32_16x16x32_bf16 v[100:103], v[196:199], a[8:11], 0
    buffer_load_dwordx4 a[68:71], v22, s[24:27], s92 offen sc1
    v_mfma_f32_16x16x32_bf16 v[104:107], v[200:203], a[8:11], 0
    v_mfma_f32_16x16x32_bf16 v[108:111], v[204:207], a[8:11], 0
    s_waitcnt vmcnt(14)
    v_mfma_f32_16x16x32_bf16 v[112:115], v[192:195], a[12:15], 0
    buffer_load_dwordx4 a[72:75], v23, s[24:27], s92 offen sc1
    v_mfma_f32_16x16x32_bf16 v[116:119], v[196:199], a[12:15], 0
    buffer_load_dwordx4 a[76:79], v24, s[24:27], s92 offen sc1
    v_mfma_f32_16x16x32_bf16 v[120:123], v[200:203], a[12:15], 0
    v_mfma_f32_16x16x32_bf16 v[124:127], v[204:207], a[12:15], 0
    s_waitcnt vmcnt(15)
    v_mfma_f32_16x16x32_bf16 v[64:67], v[208:211], a[16:19], v[64:67]
    buffer_load_dwordx4 a[80:83], v21, s[24:27], s93 offen sc1
    v_mfma_f32_16x16x32_bf16 v[68:71], v[212:215], a[16:19], v[68:71]
    v_mfma_f32_16x16x32_bf16 v[72:75], v[216:219], a[16:19], v[72:75]
    v_mfma_f32_16x16x32_bf16 v[76:79], v[220:223], a[16:19], v[76:79]
    s_waitcnt vmcnt(15)
    v_mfma_f32_16x16x32_bf16 v[80:83], v[208:211], a[20:23], v[80:83]
    buffer_load_dwordx4 a[84:87], v22, s[24:27], s93 offen sc1
    v_mfma_f32_16x16x32_bf16 v[84:87], v[212:215], a[20:23], v[84:87]
    v_mfma_f32_16x16x32_bf16 v[88:91], v[216:219], a[20:23], v[88:91]
    v_mfma_f32_16x16x32_bf16 v[92:95], v[220:223], a[20:23], v[92:95]
    s_waitcnt vmcnt(15)
    v_mfma_f32_16x16x32_bf16 v[96:99], v[208:211], a[24:27], v[96:99]
    buffer_load_dwordx4 a[88:91], v23, s[24:27], s93 offen sc1
    v_mfma_f32_16x16x32_bf16 v[100:103], v[212:215], a[24:27], v[100:103]
    v_mfma_f32_16x16x32_bf16 v[104:107], v[216:219], a[24:27], v[104:107]
    v_mfma_f32_16x16x32_bf16 v[108:111], v[220:223], a[24:27], v[108:111]
    s_waitcnt vmcnt(15)
    v_mfma_f32_16x16x32_bf16 v[112:115], v[208:211], a[28:31], v[112:115]
    buffer_load_dwordx4 a[92:95], v24, s[24:27], s93 offen sc1
    v_mfma_f32_16x16x32_bf16 v[116:119], v[212:215], a[28:31], v[116:119]
    v_mfma_f32_16x16x32_bf16 v[120:123], v[216:219], a[28:31], v[120:123]
    v_mfma_f32_16x16x32_bf16 v[124:127], v[220:223], a[28:31], v[124:127]
    s_waitcnt vmcnt(15)
    v_mfma_f32_16x16x32_bf16 v[64:67], v[224:227], a[32:35], v[64:67]
    buffer_load_dwordx4 a[96:99], v21, s[24:27], s94 offen sc1
    v_mfma_f32_16x16x32_bf16 v[68:71], v[228:231], a[32:35], v[68:71]
    v_mfma_f32_16x16x32_bf16 v[72:75], v[232:235], a[32:35], v[72:75]
    v_mfma_f32_16x16x32_bf16 v[76:79], v[236:239], a[32:35], v[76:79]
    s_waitcnt vmcnt(15)
    v_mfma_f32_16x16x32_bf16 v[80:83], v[224:227], a[36:39], v[80:83]
    buffer_load_dwordx4 a[100:103], v22, s[24:27], s94 offen sc1
    v_mfma_f32_16x16x32_bf16 v[84:87], v[228:231], a[36:39], v[84:87]
    v_mfma_f32_16x16x32_bf16 v[88:91], v[232:235], a[36:39], v[88:91]
    v_mfma_f32_16x16x32_bf16 v[92:95], v[236:239], a[36:39], v[92:95]
    s_waitcnt vmcnt(15)
    v_mfma_f32_16x16x32_bf16 v[96:99], v[224:227], a[40:43], v[96:99]
    buffer_load_dwordx4 a[104:107], v23, s[24:27], s94 offen sc1
    v_mfma_f32_16x16x32_bf16 v[100:103], v[228:231], a[40:43], v[100:103]
    v_mfma_f32_16x16x32_bf16 v[104:107], v[232:235], a[40:43], v[104:107]
    v_mfma_f32_16x16x32_bf16 v[108:111], v[236:239], a[40:43], v[108:111]
    s_waitcnt vmcnt(15)
    v_mfma_f32_16x16x32_bf16 v[112:115], v[224:227], a[44:47], v[112:115]
    buffer_load_dwordx4 a[108:111], v24, s[24:27], s94 offen sc1
    v_mfma_f32_16x16x32_bf16 v[116:119], v[228:231], a[44:47], v[116:119]
    v_mfma_f32_16x16x32_bf16 v[120:123], v[232:235], a[44:47], v[120:123]
    v_mfma_f32_16x16x32_bf16 v[124:127], v[236:239], a[44:47], v[124:127]
    s_waitcnt vmcnt(15)
    v_mfma_f32_16x16x32_bf16 v[64:67], a[176:179], a[48:51], v[64:67]
    v_mfma_f32_16x16x32_bf16 v[68:71], a[180:183], a[48:51], v[68:71]
    v_mfma_f32_16x16x32_bf16 v[72:75], a[184:187], a[48:51], v[72:75]
    v_mfma_f32_16x16x32_bf16 v[76:79], a[188:191], a[48:51], v[76:79]
    s_mov_b64 exec, 1
    v_mov_b32 v31, 0
    buffer_atomic_add v31, v26, s[24:27], 0 offen offset:1024 sc0 sc1
    s_mov_b64 exec, -1
    s_waitcnt vmcnt(15)
    v_mfma_f32_16x16x32_bf16 v[80:83], a[176:179], a[52:55], v[80:83]
    v_mfma_f32_16x16x32_bf16 v[84:87], a[180:183], a[52:55], v[84:87]
    v_mfma_f32_16x16x32_bf16 v[88:91], a[184:187], a[52:55], v[88:91]
    v_mfma_f32_16x16x32_bf16 v[92:95], a[188:191], a[52:55], v[92:95]
    s_waitcnt vmcnt(14)
    v_mfma_f32_16x16x32_bf16 v[96:99], a[176:179], a[56:59], v[96:99]
    v_mfma_f32_16x16x32_bf16 v[100:103], a[180:183], a[56:59], v[100:103]
    v_mfma_f32_16x16x32_bf16 v[104:107], a[184:187], a[56:59], v[104:107]
    v_mfma_f32_16x16x32_bf16 v[108:111], a[188:191], a[56:59], v[108:111]
    s_waitcnt vmcnt(13)
    v_mfma_f32_16x16x32_bf16 v[112:115], a[176:179], a[60:63], v[112:115]
    v_mfma_f32_16x16x32_bf16 v[116:119], a[180:183], a[60:63], v[116:119]
    v_mfma_f32_16x16x32_bf16 v[120:123], a[184:187], a[60:63], v[120:123]
    v_mfma_f32_16x16x32_bf16 v[124:127], a[188:191], a[60:63], v[124:127]
    s_waitcnt vmcnt(12)
    v_mfma_f32_16x16x32_bf16 v[64:67], a[208:211], a[64:67], v[64:67]
    v_mfma_f32_16x16x32_bf16 v[68:71], a[212:215], a[64:67], v[68:71]
    v_mfma_f32_16x16x32_bf16 v[72:75], a[216:219], a[64:67], v[72:75]
    v_mfma_f32_16x16x32_bf16 v[76:79], a[220:223], a[64:67], v[76:79]
    s_waitcnt vmcnt(11)
    v_mfma_f32_16x16x32_bf16 v[80:83], a[208:211], a[68:71], v[80:83]
    ds_read_b64_tr_b16 a[176:177], v17 offset:0
    ds_read_b64_tr_b16 a[178:179], v17 offset:2048
    v_mfma_f32_16x16x32_bf16 v[84:87], a[212:215], a[68:71], v[84:87]
    ds_read_b64_tr_b16 a[180:181], v18 offset:0
    ds_read_b64_tr_b16 a[182:183], v18 offset:2048
    v_mfma_f32_16x16x32_bf16 v[88:91], a[216:219], a[68:71], v[88:91]
    ds_read_b64_tr_b16 a[184:185], v19 offset:0
    ds_read_b64_tr_b16 a[186:187], v19 offset:2048
    v_mfma_f32_16x16x32_bf16 v[92:95], a[220:223], a[68:71], v[92:95]
    ds_read_b64_tr_b16 a[188:189], v20 offset:0
    ds_read_b64_tr_b16 a[190:191], v20 offset:2048
    s_waitcnt vmcnt(10)
    v_mfma_f32_16x16x32_bf16 v[96:99], a[208:211], a[72:75], v[96:99]
    v_mfma_f32_16x16x32_bf16 v[100:103], a[212:215], a[72:75], v[100:103]
    v_mfma_f32_16x16x32_bf16 v[104:107], a[216:219], a[72:75], v[104:107]
    v_mfma_f32_16x16x32_bf16 v[108:111], a[220:223], a[72:75], v[108:111]
    s_waitcnt vmcnt(9)
    v_mfma_f32_16x16x32_bf16 v[112:115], a[208:211], a[76:79], v[112:115]
    v_mfma_f32_16x16x32_bf16 v[116:119], a[212:215], a[76:79], v[116:119]
    v_mfma_f32_16x16x32_bf16 v[120:123], a[216:219], a[76:79], v[120:123]
    v_mfma_f32_16x16x32_bf16 v[124:127], a[220:223], a[76:79], v[124:127]
    s_waitcnt vmcnt(0)
    v_cmp_ne_u32 vcc, 0x7f, v31
    s_and_b32 s47, vcc_lo, 1
    s_cbranch_scc0 L_fastBS
    s_mov_b64 exec, 1
    v_mov_b32 v31, 0
    buffer_atomic_add v31, v26, s[24:27], 0 offen offset:1024 sc0 sc1
    s_mov_b64 exec, -1
    v_mfma_f32_16x16x32_bf16 v[64:67], a[224:227], a[80:83], v[64:67]
    v_mfma_f32_16x16x32_bf16 v[68:71], a[228:231], a[80:83], v[68:71]
    v_mfma_f32_16x16x32_bf16 v[72:75], a[232:235], a[80:83], v[72:75]
    v_mfma_f32_16x16x32_bf16 v[76:79], a[236:239], a[80:83], v[76:79]
    v_mfma_f32_16x16x32_bf16 v[80:83], a[224:227], a[84:87], v[80:83]
    ds_read_b64_tr_b16 a[208:209], v17 offset:4096
    ds_read_b64_tr_b16 a[210:211], v17 offset:6144
    v_mfma_f32_16x16x32_bf16 v[84:87], a[228:231], a[84:87], v[84:87]
    ds_read_b64_tr_b16 a[212:213], v18 offset:4096
    ds_read_b64_tr_b16 a[214:215], v18 offset:6144
    v_mfma_f32_16x16x32_bf16 v[88:91], a[232:235], a[84:87], v[88:91]
    ds_read_b64_tr_b16 a[216:217], v19 offset:4096
    ds_read_b64_tr_b16 a[218:219], v19 offset:6144
    v_mfma_f32_16x16x32_bf16 v[92:95], a[236:239], a[84:87], v[92:95]
    s_waitcnt lgkmcnt(12)
    ds_read_b64_tr_b16 a[220:221], v20 offset:4096
    ds_read_b64_tr_b16 a[222:223], v20 offset:6144
    v_mfma_f32_16x16x32_bf16 v[96:99], a[224:227], a[88:91], v[96:99]
    v_mfma_f32_16x16x32_bf16 v[100:103], a[228:231], a[88:91], v[100:103]
    v_mfma_f32_16x16x32_bf16 v[104:107], a[232:235], a[88:91], v[104:107]
    v_mfma_f32_16x16x32_bf16 v[108:111], a[236:239], a[88:91], v[108:111]
    v_mfma_f32_16x16x32_bf16 v[112:115], a[224:227], a[92:95], v[112:115]
    v_mfma_f32_16x16x32_bf16 v[116:119], a[228:231], a[92:95], v[116:119]
    v_mfma_f32_16x16x32_bf16 v[120:123], a[232:235], a[92:95], v[120:123]
    v_mfma_f32_16x16x32_bf16 v[124:127], a[236:239], a[92:95], v[124:127]
    v_mfma_f32_16x16x32_bf16 v[64:67], a[240:243], a[96:99], v[64:67]
    v_mfma_f32_16x16x32_bf16 v[68:71], a[244:247], a[96:99], v[68:71]
    v_mfma_f32_16x16x32_bf16 v[72:75], a[248:251], a[96:99], v[72:75]
    v_mfma_f32_16x16x32_bf16 v[76:79], a[252:255], a[96:99], v[76:79]
    v_mfma_f32_16x16x32_bf16 v[80:83], a[240:243], a[100:103], v[80:83]
    v_mfma_f32_16x16x32_bf16 v[84:87], a[244:247], a[100:103], v[84:87]
    v_mfma_f32_16x16x32_bf16 v[88:91], a[248:251], a[100:103], v[88:91]
    v_mfma_f32_16x16x32_bf16 v[92:95], a[252:255], a[100:103], v[92:95]
    v_mfma_f32_16x16x32_bf16 v[96:99], a[240:243], a[104:107], v[96:99]
    v_mfma_f32_16x16x32_bf16 v[100:103], a[244:247], a[104:107], v[100:103]
    v_mfma_f32_16x16x32_bf16 v[104:107], a[248:251], a[104:107], v[104:107]
    v_mfma_f32_16x16x32_bf16 v[108:111], a[252:255], a[104:107], v[108:111]
    v_mfma_f32_16x16x32_bf16 v[112:115], a[240:243], a[108:111], v[112:115]
    v_mfma_f32_16x16x32_bf16 v[116:119], a[244:247], a[108:111], v[116:119]
    v_mfma_f32_16x16x32_bf16 v[120:123], a[248:251], a[108:111], v[120:123]
    v_mfma_f32_16x16x32_bf16 v[124:127], a[252:255], a[108:111], v[124:127]
    s_waitcnt lgkmcnt(0)
    s_waitcnt vmcnt(0)
    v_cmp_ne_u32 vcc, 0x7f, v31
    s_and_b32 s47, vcc_lo, 1
    s_cbranch_scc0 L_pbS_ok
    s_mov_b32 s51, 0x20000
L_pbS:
    s_mov_b64 exec, 1
    v_mov_b32 v28, 0
    buffer_atomic_add v28, v26, s[24:27], 0 offen offset:1024 sc0 sc1
    s_mov_b64 exec, -1
    s_waitcnt vmcnt(0)
    v_cmp_ne_u32 vcc, 0x7f, v28
    s_and_b32 s47, vcc_lo, 1
    s_cbranch_scc0 L_pbS_ok
    s_sub_u32 s51, s51, 1
    s_cmp_lg_u32 s51, 0
    s_cbranch_scc1 L_pbS
L_pbS_ok:
    s_add_u32 s88, s88, 57344
    s_add_u32 s89, s89, 57344
    s_add_u32 s90, s90, 57344
    s_add_u32 s91, s91, 57344
    s_add_u32 s92, s92, 57344
    s_add_u32 s93, s93, 57344
    s_add_u32 s94, s94, 57344
    buffer_load_dwordx4 v[128:131], v22, s[24:27], s88 offen sc1
    buffer_load_dwordx4 v[132:135], v22, s[24:27], s89 offen sc1
    buffer_load_dwordx4 v[136:139], v22, s[24:27], s90 offen sc1
    buffer_load_dwordx4 v[140:143], v22, s[24:27], s91 offen sc1
    buffer_load_dwordx4 v[144:147], v22, s[24:27], s92 offen sc1
    buffer_load_dwordx4 v[148:151], v22, s[24:27], s93 offen sc1
    buffer_load_dwordx4 v[152:155], v22, s[24:27], s94 offen sc1
    buffer_load_dwordx4 v[156:159], v23, s[24:27], s88 offen sc1
    buffer_load_dwordx4 v[160:163], v23, s[24:27], s89 offen sc1
    buffer_load_dwordx4 v[164:167], v23, s[24:27], s90 offen sc1
    buffer_load_dwordx4 v[168:171], v23, s[24:27], s91 offen sc1
    buffer_load_dwordx4 v[172:175], v23, s[24:27], s92 offen sc1
    s_branch L_B
L_fastBS:
    v_mfma_f32_16x16x32_bf16 v[64:67], a[224:227], a[80:83], v[64:67]
    s_add_u32 s88, s88, 57344
    s_add_u32 s89, s89, 57344
    s_add_u32 s90, s90, 57344
    s_add_u32 s91, s91, 57344
    s_add_u32 s92, s92, 57344
    s_add_u32 s93, s93, 57344
    s_add_u32 s94, s94, 57344
    buffer_load_dwordx4 v[128:131], v22, s[24:27], s88 offen sc1
    v_mfma_f32_16x16x32_bf16 v[68:71], a[228:231], a[80:83], v[68:71]
    buffer_load_dwordx4 v[132:135], v22, s[24:27], s89 offen sc1
    v_mfma_f32_16x16x32_bf16 v[72:75], a[232:235], a[80:83], v[72:75]
    v_mfma_f32_16x16x32_bf16 v[76:79], a[236:239], a[80:83], v[76:79]
    v_mfma_f32_16x16x32_bf16 v[80:83], a[224:227], a[84:87], v[80:83]
    buffer_load_dwordx4 v[136:139], v22, s[24:27], s90 offen sc1
    ds_read_b64_tr_b16 a[208:209], v17 offset:4096
    v_mfma_f32_16x16x32_bf16 v[84:87], a[228:231], a[84:87], v[84:87]
    buffer_load_dwordx4 v[140:143], v22, s[24:27], s91 offen sc1
    ds_read_b64_tr_b16 a[210:211], v17 offset:6144
    v_mfma_f32_16x16x32_bf16 v[88:91], a[232:235], a[84:87], v[88:91]
    ds_read_b64_tr_b16 a[212:213], v18 offset:4096
    ds_read_b64_tr_b16 a[214:215], v18 offset:6144
    v_mfma_f32_16x16x32_bf16 v[92:95], a[236:239], a[84:87], v[92:95]
    ds_read_b64_tr_b16 a[216:217], v19 offset:4096
    ds_read_b64_tr_b16 a[218:219], v19 offset:6144
    v_mfma_f32_16x16x32_bf16 v[96:99], a[224:227], a[88:91], v[96:99]
    buffer_load_dwordx4 v[144:147], v22, s[24:27], s92 offen sc1
    s_waitcnt lgkmcnt(12)
    ds_read_b64_tr_b16 a[220:221], v20 offset:4096
    v_mfma_f32_16x16x32_bf16 v[100:103], a[228:231], a[88:91], v[100:103]
    buffer_load_dwordx4 v[148:151], v22, s[24:27], s93 offen sc1
    ds_read_b64_tr_b16 a[222:223], v20 offset:6144
    v_mfma_f32_16x16x32_bf16 v[104:107], a[232:235], a[88:91], v[104:107]
    v_mfma_f32_16x16x32_bf16 v[108:111], a[236:239], a[88:91], v[108:111]
    v_mfma_f32_16x16x32_bf16 v[112:115], a[224:227], a[92:95], v[112:115]
    buffer_load_dwordx4 v[152:155], v22, s[24:27], s94 offen sc1
    v_mfma_f32_16x16x32_bf16 v[116:119], a[228:231], a[92:95], v[116:119]
    buffer_load_dwordx4 v[156:159], v23, s[24:27], s88 offen sc1
    v_mfma_f32_16x16x32_bf16 v[120:123], a[232:235], a[92:95], v[120:123]
    v_mfma_f32_16x16x32_bf16 v[124:127], a[236:239], a[92:95], v[124:127]
    v_mfma_f32_16x16x32_bf16 v[64:67], a[240:243], a[96:99], v[64:67]
    buffer_load_dwordx4 v[160:163], v23, s[24:27], s89 offen sc1
    v_mfma_f32_16x16x32_bf16 v[68:71], a[244:247], a[96:99], v[68:71]
    buffer_load_dwordx4 v[164:167], v23, s[24:27], s90 offen sc1
    v_mfma_f32_16x16x32_bf16 v[72:75], a[248:251], a[96:99], v[72:75]
    v_mfma_f32_16x16x32_bf16 v[76:79], a[252:255], a[96:99], v[76:79]
    v_mfma_f32_16x16x32_bf16 v[80:83], a[240:243], a[100:103], v[80:83]
    buffer_load_dwordx4 v[168:171], v23, s[24:27], s91 offen sc1
    v_mfma_f32_16x16x32_bf16 v[84:87], a[244:247], a[100:103], v[84:87]
    buffer_load_dwordx4 v[172:175], v23, s[24:27], s92 offen sc1
    v_mfma_f32_16x16x32_bf16 v[88:91], a[248:251], a[100:103], v[88:91]
    v_mfma_f32_16x16x32_bf16 v[92:95], a[252:255], a[100:103], v[92:95]
    v_mfma_f32_16x16x32_bf16 v[96:99], a[240:243], a[104:107], v[96:99]
    v_mfma_f32_16x16x32_bf16 v[100:103], a[244:247], a[104:107], v[100:103]
    v_mfma_f32_16x16x32_bf16 v[104:107], a[248:251], a[104:107], v[104:107]
    v_mfma_f32_16x16x32_bf16 v[108:111], a[252:255], a[104:107], v[108:111]
    v_mfma_f32_16x16x32_bf16 v[112:115], a[240:243], a[108:111], v[112:115]
    v_mfma_f32_16x16x32_bf16 v[116:119], a[244:247], a[108:111], v[116:119]
    v_mfma_f32_16x16x32_bf16 v[120:123], a[248:251], a[108:111], v[120:123]
    v_mfma_f32_16x16x32_bf16 v[124:127], a[252:255], a[108:111], v[124:127]
    s_waitcnt lgkmcnt(0)
L_B:
    s_waitcnt vmcnt(11)
    v_mfma_f32_16x16x32_bf16 v[80:83], a[128:131], v[128:131], v[80:83]
    buffer_load_dwordx4 v[176:179], v23, s[24:27], s93 offen sc1
    v_mfma_f32_16x16x32_bf16 v[84:87], a[132:135], v[128:131], v[84:87]
    v_mfma_f32_16x16x32_bf16 v[88:91], a[136:139], v[128:131], v[88:91]
    v_mfma_f32_16x16x32_bf16 v[92:95], a[140:143], v[128:131], v[92:95]
    s_waitcnt vmcnt(11)
    v_mfma_f32_16x16x32_bf16 v[80:83], a[144:147], v[132:135], v[80:83]
    buffer_load_dwordx4 v[180:183], v23, s[24:27], s94 offen sc1
    v_mfma_f32_16x16x32_bf16 v[84:87], a[148:151], v[132:135], v[84:87]
    v_mfma_f32_16x16x32_bf16 v[88:91], a[152:155], v[132:135], v[88:91]
    v_mfma_f32_16x16x32_bf16 v[92:95], a[156:159], v[132:135], v[92:95]
    s_waitcnt vmcnt(11)
    v_mfma_f32_16x16x32_bf16 v[80:83], a[160:163], v[136:139], v[80:83]
    buffer_load_dwordx4 v[184:187], v24, s[24:27], s88 offen sc1
    v_mfma_f32_16x16x32_bf16 v[84:87], a[164:167], v[136:139], v[84:87]
    v_mfma_f32_16x16x32_bf16 v[88:91], a[168:171], v[136:139], v[88:91]
    v_mfma_f32_16x16x32_bf16 v[92:95], a[172:175], v[136:139], v[92:95]
    s_waitcnt vmcnt(11)
    v_mfma_f32_16x16x32_bf16 v[80:83], a[192:195], v[140:143], v[80:83]
    buffer_load_dwordx4 v[188:191], v24, s[24:27], s89 offen sc1
    v_mfma_f32_16x16x32_bf16 v[84:87], a[196:199], v[140:143], v[84:87]
    v_mfma_f32_16x16x32_bf16 v[88:91], a[200:203], v[140:143], v[88:91]
    v_mfma_f32_16x16x32_bf16 v[92:95], a[204:207], v[140:143], v[92:95]
    s_waitcnt vmcnt(11)
    v_mfma_f32_16x16x32_bf16 v[80:83], a[112:115], v[144:147], v[80:83]
    buffer_load_dwordx4 v[192:195], v24, s[24:27], s90 offen sc1
    v_mfma_f32_16x16x32_bf16 v[84:87], a[116:119], v[144:147], v[84:87]
    v_mfma_f32_16x16x32_bf16 v[88:91], a[120:123], v[144:147], v[88:91]
    v_mfma_f32_16x16x32_bf16 v[92:95], a[124:127], v[144:147], v[92:95]
    s_waitcnt vmcnt(11)
    v_mfma_f32_16x16x32_bf16 v[80:83], a[176:179], v[148:151], v[80:83]
    buffer_load_dwordx4 v[196:199], v24, s[24:27], s91 offen sc1
    v_mfma_f32_16x16x32_bf16 v[84:87], a[180:183], v[148:151], v[84:87]
    v_mfma_f32_16x16x32_bf16 v[88:91], a[184:187], v[148:151], v[88:91]
    v_mfma_f32_16x16x32_bf16 v[92:95], a[188:191], v[148:151], v[92:95]
    s_waitcnt vmcnt(11)
    v_mfma_f32_16x16x32_bf16 v[80:83], a[208:211], v[152:155], v[80:83]
    buffer_load_dwordx4 v[200:203], v24, s[24:27], s92 offen sc1
    v_mfma_f32_16x16x32_bf16 v[84:87], a[212:215], v[152:155], v[84:87]
    v_mfma_f32_16x16x32_bf16 v[88:91], a[216:219], v[152:155], v[88:91]
    v_mfma_f32_16x16x32_bf16 v[92:95], a[220:223], v[152:155], v[92:95]
    s_waitcnt vmcnt(11)
    v_mfma_f32_16x16x32_bf16 v[96:99], a[128:131], v[156:159], v[96:99]
    buffer_load_dwordx4 v[204:207], v24, s[24:27], s93 offen sc1
    v_mfma_f32_16x16x32_bf16 v[100:103], a[132:135], v[156:159], v[100:103]
    v_mfma_f32_16x16x32_bf16 v[104:107], a[136:139], v[156:159], v[104:107]
    v_mfma_f32_16x16x32_bf16 v[108:111], a[140:143], v[156:159], v[108:111]
    s_waitcnt vmcnt(11)
    v_mfma_f32_16x16x32_bf16 v[96:99], a[144:147], v[160:163], v[96:99]
    buffer_load_dwordx4 v[208:211], v24, s[24:27], s94 offen sc1
    v_mfma_f32_16x16x32_bf16 v[100:103], a[148:151], v[160:163], v[100:103]
    v_mfma_f32_16x16x32_bf16 v[104:107], a[152:155], v[160:163], v[104:107]
    v_mfma_f32_16x16x32_bf16 v[108:111], a[156:159], v[160:163], v[108:111]
    s_waitcnt vmcnt(11)
    v_mfma_f32_16x16x32_bf16 v[96:99], a[160:163], v[164:167], v[96:99]
    buffer_load_dwordx4 v[212:215], v21, s[24:27], s88 offen sc1
    v_mfma_f32_16x16x32_bf16 v[100:103], a[164:167], v[164:167], v[100:103]
    ds_write_b128 v8, v[80:83] offset:0
    v_mfma_f32_16x16x32_bf16 v[104:107], a[168:171], v[164:167], v[104:107]
    v_mfma_f32_16x16x32_bf16 v[108:111], a[172:175], v[164:167], v[108:111]
    s_waitcnt vmcnt(11)
    v_mfma_f32_16x16x32_bf16 v[96:99], a[192:195], v[168:171], v[96:99]
    buffer_load_dwordx4 v[216:219], v21, s[24:27], s89 offen sc1
    v_mfma_f32_16x16x32_bf16 v[100:103], a[196:199], v[168:171], v[100:103]
    ds_write_b128 v8, v[84:87] offset:1024
    v_mfma_f32_16x16x32_bf16 v[104:107], a[200:203], v[168:171], v[104:107]
    v_mfma_f32_16x16x32_bf16 v[108:111], a[204:207], v[168:171], v[108:111]
    s_waitcnt vmcnt(11)
    v_mfma_f32_16x16x32_bf16 v[96:99], a[112:115], v[172:175], v[96:99]
    buffer_load_dwordx4 v[220:223], v21, s[24:27], s90 offen sc1
    v_mfma_f32_16x16x32_bf16 v[100:103], a[116:119], v[172:175], v[100:103]
    ds_write_b128 v8, v[88:91] offset:2048
    v_mfma_f32_16x16x32_bf16 v[104:107], a[120:123], v[172:175], v[104:107]
    v_mfma_f32_16x16x32_bf16 v[108:111], a[124:127], v[172:175], v[108:111]
    s_waitcnt vmcnt(11)
    v_mfma_f32_16x16x32_bf16 v[96:99], a[176:179], v[176:179], v[96:99]
    buffer_load_dwordx4 v[224:227], v21, s[24:27], s91 offen sc1
    v_mfma_f32_16x16x32_bf16 v[100:103], a[180:183], v[176:179], v[100:103]
    ds_write_b128 v8, v[92:95] offset:3072
    v_mfma_f32_16x16x32_bf16 v[104:107], a[184:187], v[176:179], v[104:107]
    v_mfma_f32_16x16x32_bf16 v[108:111], a[188:191], v[176:179], v[108:111]
    s_waitcnt vmcnt(11)
    v_mfma_f32_16x16x32_bf16 v[96:99], a[208:211], v[180:183], v[96:99]
    buffer_load_dwordx4 v[228:231], v21, s[24:27], s92 offen sc1
    v_mfma_f32_16x16x32_bf16 v[100:103], a[212:215], v[180:183], v[100:103]
    v_mfma_f32_16x16x32_bf16 v[104:107], a[216:219], v[180:183], v[104:107]
    v_mfma_f32_16x16x32_bf16 v[108:111], a[220:223], v[180:183], v[108:111]
    s_waitcnt vmcnt(11)
    v_mfma_f32_16x16x32_bf16 v[112:115], a[128:131], v[184:187], v[112:115]
    buffer_load_dwordx4 v[232:235], v21, s[24:27], s93 offen sc1
    v_mfma_f32_16x16x32_bf16 v[116:119], a[132:135], v[184:187], v[116:119]
    v_mfma_f32_16x16x32_bf16 v[120:123], a[136:139], v[184:187], v[120:123]
    v_mfma_f32_16x16x32_bf16 v[124:127], a[140:143], v[184:187], v[124:127]
    s_waitcnt vmcnt(11)
    v_mfma_f32_16x16x32_bf16 v[112:115], a[144:147], v[188:191], v[112:115]
    buffer_load_dwordx4 v[236:239], v21, s[24:27], s94 offen sc1
    v_mfma_f32_16x16x32_bf16 v[116:119], a[148:151], v[188:191], v[116:119]
    v_mfma_f32_16x16x32_bf16 v[120:123], a[152:155], v[188:191], v[120:123]
    v_mfma_f32_16x16x32_bf16 v[124:127], a[156:159], v[188:191], v[124:127]
    s_waitcnt vmcnt(11)
    v_mfma_f32_16x16x32_bf16 v[112:115], a[160:163], v[192:195], v[112:115]
    v_mfma_f32_16x16x32_bf16 v[116:119], a[164:167], v[192:195], v[116:119]
    ds_write_b128 v8, v[96:99] offset:4096
    v_mfma_f32_16x16x32_bf16 v[120:123], a[168:171], v[192:195], v[120:123]
    v_mfma_f32_16x16x32_bf16 v[124:127], a[172:175], v[192:195], v[124:127]
    s_waitcnt vmcnt(10)
    v_mfma_f32_16x16x32_bf16 v[112:115], a[192:195], v[196:199], v[112:115]
    v_mfma_f32_16x16x32_bf16 v[116:119], a[196:199], v[196:199], v[116:119]
    ds_write_b128 v8, v[100:103] offset:5120
    v_mfma_f32_16x16x32_bf16 v[120:123], a[200:203], v[196:199], v[120:123]
    v_mfma_f32_16x16x32_bf16 v[124:127], a[204:207], v[196:199], v[124:127]
    s_waitcnt vmcnt(9)
    v_mfma_f32_16x16x32_bf16 v[112:115], a[112:115], v[200:203], v[112:115]
    v_mfma_f32_16x16x32_bf16 v[116:119], a[116:119], v[200:203], v[116:119]
    ds_write_b128 v8, v[104:107] offset:6144
    v_mfma_f32_16x16x32_bf16 v[120:123], a[120:123], v[200:203], v[120:123]
    v_mfma_f32_16x16x32_bf16 v[124:127], a[124:127], v[200:203], v[124:127]
    s_waitcnt vmcnt(8)
    v_mfma_f32_16x16x32_bf16 v[112:115], a[176:179], v[204:207], v[112:115]
    v_mfma_f32_16x16x32_bf16 v[116:119], a[180:183], v[204:207], v[116:119]
    ds_write_b128 v8, v[108:111] offset:7168
    v_mfma_f32_16x16x32_bf16 v[120:123], a[184:187], v[204:207], v[120:123]
    v_mfma_f32_16x16x32_bf16 v[124:127], a[188:191], v[204:207], v[124:127]
    s_waitcnt vmcnt(7)
    v_mfma_f32_16x16x32_bf16 v[112:115], a[208:211], v[208:211], v[112:115]
    v_mfma_f32_16x16x32_bf16 v[116:119], a[212:215], v[208:211], v[116:119]
    v_mfma_f32_16x16x32_bf16 v[120:123], a[216:219], v[208:211], v[120:123]
    v_mfma_f32_16x16x32_bf16 v[124:127], a[220:223], v[208:211], v[124:127]
    s_waitcnt vmcnt(6)
    v_mfma_f32_16x16x32_bf16 v[64:67], a[128:131], v[212:215], v[64:67]
    v_mfma_f32_16x16x32_bf16 v[68:71], a[132:135], v[212:215], v[68:71]
    v_mfma_f32_16x16x32_bf16 v[72:75], a[136:139], v[212:215], v[72:75]
    v_mfma_f32_16x16x32_bf16 v[76:79], a[140:143], v[212:215], v[76:79]
    s_waitcnt vmcnt(5)
    v_mfma_f32_16x16x32_bf16 v[64:67], a[144:147], v[216:219], v[64:67]
    v_mfma_f32_16x16x32_bf16 v[68:71], a[148:151], v[216:219], v[68:71]
    v_mfma_f32_16x16x32_bf16 v[72:75], a[152:155], v[216:219], v[72:75]
    v_mfma_f32_16x16x32_bf16 v[76:79], a[156:159], v[216:219], v[76:79]
    s_waitcnt vmcnt(4)
    v_mfma_f32_16x16x32_bf16 v[64:67], a[160:163], v[220:223], v[64:67]
    ds_write_b128 v8, v[112:115] offset:8192
    v_mfma_f32_16x16x32_bf16 v[68:71], a[164:167], v[220:223], v[68:71]
    ds_write_b128 v8, v[116:119] offset:9216
    v_mfma_f32_16x16x32_bf16 v[72:75], a[168:171], v[220:223], v[72:75]
    ds_write_b128 v8, v[120:123] offset:10240
    v_mfma_f32_16x16x32_bf16 v[76:79], a[172:175], v[220:223], v[76:79]
    ds_write_b128 v8, v[124:127] offset:11264
    s_waitcnt vmcnt(3)
    v_mfma_f32_16x16x32_bf16 v[64:67], a[192:195], v[224:227], v[64:67]
    v_mfma_f32_16x16x32_bf16 v[68:71], a[196:199], v[224:227], v[68:71]
    v_mfma_f32_16x16x32_bf16 v[72:75], a[200:203], v[224:227], v[72:75]
    v_mfma_f32_16x16x32_bf16 v[76:79], a[204:207], v[224:227], v[76:79]
    s_waitcnt vmcnt(2)
    v_mfma_f32_16x16x32_bf16 v[64:67], a[112:115], v[228:231], v[64:67]
    v_mfma_f32_16x16x32_bf16 v[68:71], a[116:119], v[228:231], v[68:71]
    s_waitcnt lgkmcnt(0)
    s_barrier
    ds_read_b128 v[80:83], v5 offset:0
    ds_read_b128 v[96:99], v6 offset:0
    ds_read_b128 v[112:115], v7 offset:0
    ds_read_b128 v[84:87], v5 offset:1024
    ds_read_b128 v[100:103], v6 offset:1024
    ds_read_b128 v[116:119], v7 offset:1024
    ds_read_b128 v[88:91], v5 offset:2048
    ds_read_b128 v[104:107], v6 offset:2048
    ds_read_b128 v[120:123], v7 offset:2048
    ds_read_b128 v[92:95], v5 offset:3072
    ds_read_b128 v[108:111], v6 offset:3072
    ds_read_b128 v[124:127], v7 offset:3072
    v_mfma_f32_16x16x32_bf16 v[72:75], a[120:123], v[228:231], v[72:75]
    v_mfma_f32_16x16x32_bf16 v[76:79], a[124:127], v[228:231], v[76:79]
    s_waitcnt vmcnt(1)
    v_mfma_f32_16x16x32_bf16 v[64:67], a[176:179], v[232:235], v[64:67]
    v_mfma_f32_16x16x32_bf16 v[68:71], a[180:183], v[232:235], v[68:71]
    v_mfma_f32_16x16x32_bf16 v[72:75], a[184:187], v[232:235], v[72:75]
    v_mfma_f32_16x16x32_bf16 v[76:79], a[188:191], v[232:235], v[76:79]
    s_waitcnt vmcnt(0)
    v_mfma_f32_16x16x32_bf16 v[64:67], a[208:211], v[236:239], v[64:67]
    v_mfma_f32_16x16x32_bf16 v[68:71], a[212:215], v[236:239], v[68:71]
    v_mfma_f32_16x16x32_bf16 v[72:75], a[216:219], v[236:239], v[72:75]
    v_mfma_f32_16x16x32_bf16 v[76:79], a[220:223], v[236:239], v[76:79]
    s_waitcnt lgkmcnt(9)
    v_pk_add_f32 v[80:81], v[80:81], v[96:97]
    v_pk_add_f32 v[82:83], v[82:83], v[98:99]
    v_pk_add_f32 v[80:81], v[80:81], v[112:113]
    v_pk_add_f32 v[82:83], v[82:83], v[114:115]
    s_waitcnt lgkmcnt(6)
    v_pk_add_f32 v[84:85], v[84:85], v[100:101]
    v_pk_add_f32 v[86:87], v[86:87], v[102:103]
    v_pk_add_f32 v[84:85], v[84:85], v[116:117]
    v_pk_add_f32 v[86:87], v[86:87], v[118:119]
    s_waitcnt lgkmcnt(3)
    v_pk_add_f32 v[88:89], v[88:89], v[104:105]
    v_pk_add_f32 v[90:91], v[90:91], v[106:107]
    v_pk_add_f32 v[88:89], v[88:89], v[120:121]
    v_pk_add_f32 v[90:91], v[90:91], v[122:123]
    s_waitcnt lgkmcnt(0)
    v_pk_add_f32 v[92:93], v[92:93], v[108:109]
    v_pk_add_f32 v[94:95], v[94:95], v[110:111]
    v_pk_add_f32 v[92:93], v[92:93], v[124:125]
    v_pk_add_f32 v[94:95], v[94:95], v[126:127]
    v_pk_add_f32 v[64:65], v[64:65], v[80:81]
    v_pk_add_f32 v[66:67], v[66:67], v[82:83]
    v_pk_add_f32 v[68:69], v[68:69], v[84:85]
    v_pk_add_f32 v[70:71], v[70:71], v[86:87]
    v_pk_add_f32 v[72:73], v[72:73], v[88:89]
    v_pk_add_f32 v[74:75], v[74:75], v[90:91]
    v_pk_add_f32 v[76:77], v[76:77], v[92:93]
    v_pk_add_f32 v[78:79], v[78:79], v[94:95]
    v_cvt_pk_bf16_f32 v240, v64, v65
    v_cvt_pk_bf16_f32 v241, v66, v67
    v_cvt_pk_bf16_f32 v242, v68, v69
    v_cvt_pk_bf16_f32 v243, v70, v71
    v_cvt_pk_bf16_f32 v244, v72, v73
    v_cvt_pk_bf16_f32 v245, v74, v75
    v_cvt_pk_bf16_f32 v246, v76, v77
    v_cvt_pk_bf16_f32 v247, v78, v79
    s_nop 1
    v_permlane16_swap_b32 v240, v242
    v_permlane16_swap_b32 v241, v243
    v_permlane16_swap_b32 v244, v246
    v_permlane16_swap_b32 v245, v247
    ds_bpermute_b32 v248, v15, v240
    ds_bpermute_b32 v249, v15, v241
    ds_bpermute_b32 v250, v15, v242
    ds_bpermute_b32 v251, v15, v243
    ds_bpermute_b32 v252, v15, v244
    ds_bpermute_b32 v253, v15, v245
    ds_bpermute_b32 v254, v15, v246
    ds_bpermute_b32 v255, v15, v247
    s_waitcnt lgkmcnt(4)
    buffer_store_dwordx4 v[248:251], v13, s[28:31], s54 offen
    s_waitcnt lgkmcnt(0)
    buffer_store_dwordx4 v[252:255], v13, s[28:31], s54 offen offset:64
L_end:
    s_endpgm
L_codeend:
.section .rodata,"a"
.p2align 10
.amdhsa_kernel standalone__glu_gated_bilinear__prompt_kernel
  .amdhsa_next_free_vgpr 512
  .amdhsa_next_free_sgpr 102
  .amdhsa_accum_offset 256
  .amdhsa_group_segment_fixed_size 0
  .amdhsa_kernarg_size 56
  .amdhsa_user_sgpr_count 2
  .amdhsa_user_sgpr_kernarg_segment_ptr 1
  .amdhsa_system_sgpr_workgroup_id_x 1
  .amdhsa_float_denorm_mode_32 3
.end_amdhsa_kernel
```
